```python
import torch

def _softmax(x, axis=-1):
    return torch.softmax(x, dim=axis)
def _gelu(x):
    return torch.nn.functional.gelu(x, approximate="tanh")
def _silu(x):
    return torch.nn.functional.silu(x)
def _sigmoid(x):
    return torch.sigmoid(x)
def _layernorm(x, axis=-1, eps=1e-5):
    m = x.mean(dim=axis, keepdim=True)
    v = x.var(dim=axis, keepdim=True, unbiased=False)
    return (x - m) / torch.sqrt(v + eps)
def _scatter_add(tgt, idx, src, axis=0):
    return tgt.clone().index_add_(axis, idx, src)
def _segment_sum(src, seg, n):
    out = torch.zeros((n,) + src.shape[1:], dtype=src.dtype)
    return out.index_add_(0, seg, src)
def _pad(x, pw):
    flat = tuple(v for pair in reversed(pw) for v in pair)
    return torch.nn.functional.pad(x, flat)

kernel_name = 'concat_heads__sliding_block_cached__compressed_kv_cla__decode'

def setup_inputs():

    _w = (lambda a: (lambda t: t.to(torch.bfloat16) if t.is_floating_point() else t)(torch.as_tensor(a)))
    def _A_setup():
        B, Sq, D = 4, 1, 512
        Hq, Hkv, Sk, Dh = 32, 8, 4096, 128
        assert Hq % Hkv == 0, (Hq, Hkv)
        return {
            "x": _w((lambda *s: torch.randn(*s, dtype=torch.bfloat16) * 0.8)(B, Sq, D)),
            "k_cache": _w((lambda *s: torch.randn(*s, dtype=torch.bfloat16) * 0.8)(B, Hkv, Sk, Dh)),
            "v_cache": _w((lambda *s: torch.randn(*s, dtype=torch.bfloat16) * 0.05)(B, Hkv, Sk, Dh)),
            "wq": _w((lambda *s: torch.randn(*s, dtype=torch.bfloat16) * 0.8)(D, Hq * Dh) * (D ** -0.5)),
            "wo": _w((lambda *s: torch.randn(*s, dtype=torch.bfloat16) * 0.05)(Hq * Dh, D) * ((Hq * Dh) ** -0.5)),
        }
    _A_in = _A_setup()

    def _B_setup():
        B, H, Sq, Sk, D, M = 4, 32, 1, 4096, 128, 512
        Dc = 4 * D
        return {
            "x": _w((lambda *s: torch.randn(*s, dtype=torch.bfloat16) * 1.6)(B, Sq, M)),
            "c_kv": _w((lambda *s: torch.randn(*s, dtype=torch.bfloat16) * 0.1)(B, Sk, Dc)),
            "w_q": _w((lambda *s: torch.randn(*s, dtype=torch.bfloat16) * 3.2)(M, H, D) * (M ** -0.5)),
            "w_uk": _w((lambda *s: torch.randn(*s, dtype=torch.bfloat16) * 3.2)(Dc, H, D) * (Dc ** -0.5)),
            "w_uv": _w((lambda *s: torch.randn(*s, dtype=torch.bfloat16) * 0.1)(Dc, H, D) * (Dc ** -0.5)),
            "w_o": _w((lambda *s: torch.randn(*s, dtype=torch.bfloat16) * 0.1)(H, D, M) * ((H * D) ** -0.5)),
        }
    _B_in = _B_setup()

    return {
        "A_x": _A_in["x"],
        "A_k_cache": _A_in["k_cache"],
        "A_v_cache": _A_in["v_cache"],
        "A_wq": _A_in["wq"],
        "A_wo": _A_in["wo"],
        "B_x": _B_in["x"],
        "B_c_kv": _B_in["c_kv"],
        "B_w_q": _B_in["w_q"],
        "B_w_uk": _B_in["w_uk"],
        "B_w_uv": _B_in["w_uv"],
        "B_w_o": _B_in["w_o"],
    }

def reference(A_x, A_k_cache, A_v_cache, A_wq, A_wo, B_x, B_c_kv, B_w_q, B_w_uk, B_w_uv, B_w_o):
    def _A_ref(x, k_cache, v_cache, wq, wo):
        B, Sq, D = x.shape
        Hq, Dh = 32, 128
        Hkv, Sk = k_cache.shape[1], k_cache.shape[2]
        W = min(4096, max(256, Sk // 4))
        rep = Hq // Hkv
        q = (lambda x, *d: x.permute(*d))((x @ wq).reshape(B, Sq, Hq, Dh), 0, 2, 1, 3)
        k = (lambda x, n, axis: torch.repeat_interleave(x, n, dim=axis))(k_cache[:, :, Sk - W:, :], rep, axis=1)
        v = (lambda x, n, axis: torch.repeat_interleave(x, n, dim=axis))(v_cache[:, :, Sk - W:, :], rep, axis=1)
        scores = torch.einsum("bhqd,bhkd->bhqk", q, k) * (Dh ** -0.5)
        p = _softmax(scores, axis=-1)
        o = torch.einsum("bhqk,bhkd->bhqd", p, v)
        return (lambda x, *d: x.permute(*d))(o, 0, 2, 1, 3).reshape(B, Sq, Hq * Dh) @ wo

    def _B_ref(x, c_kv, w_q, w_uk, w_uv, w_o):
        B, Sq, M = x.shape[0], x.shape[1], x.shape[2]
        Sk = c_kv.shape[1]
        H, D = w_q.shape[1], w_q.shape[2]
        q = torch.einsum("bqm,mhd->bhqd", x, w_q)
        k = torch.einsum("bkc,chd->bhkd", c_kv, w_uk)
        v = torch.einsum("bkc,chd->bhkd", c_kv, w_uv)
        scores = torch.einsum("bhqd,bhkd->bhqk", q, k) * (D ** -0.5)
        off = Sk - Sq
        qi = torch.arange(Sq)[:, None]
        kj = torch.arange(Sk)[None, :]
        cmask = kj <= (qi + off)
        scores = torch.where(cmask[None, None], scores, -1e9)
        p = _softmax(scores, axis=-1)
        ctx = torch.einsum("bhqk,bhkd->bhqd", p, v)
        return torch.einsum("bhqd,hdm->bqm", ctx, w_o)

    a = _A_ref(A_x, A_k_cache, A_v_cache, A_wq, A_wo)
    b = _B_ref(B_x, B_c_kv, B_w_q, B_w_uk, B_w_uv, B_w_o)
    return torch.concatenate([a, b], axis=-1)
```

```asm
; @launch grid=(256,1,1) block=(256,1,1) lds=163840
.amdgcn_target "amdgcn-amd-amdhsa--gfx950"
.text
.globl concat_heads__sliding_block_cached__compressed_kv_cla__decode_kernel
.p2align 8
.type concat_heads__sliding_block_cached__compressed_kv_cla__decode_kernel,@function
concat_heads__sliding_block_cached__compressed_kv_cla__decode_kernel:
    s_lshr_b32 s57, s2, 8
    s_cbranch_scc1 L_end
    s_load_dwordx16 s[16:31], s[0:1], 48
    s_load_dwordx2 s[14:15], s[0:1], 40
    s_lshr_b32 s53, s2, 3
    s_lshl_b32 s57, s53, 9
    s_and_b32 s53, s53, 15
    s_getpc_b64 s[58:59]
    v_lshrrev_b32 v16, 6, v0
    v_lshl_add_u32 v17, v16, 7, s57
    global_load_dword v255, v17, s[58:59]
    v_readfirstlane_b32 s52, v16
    v_and_b32 v1, 63, v0
    v_lshrrev_b32 v3, 4, v1
    v_lshlrev_b32 v4, 4, v1
    s_and_b32 s57, s2, 7
    s_lshl2_add_u32 s43, s53, s52
    s_lshl_b32 s43, s43, 6
    s_lshl4_add_u32 s53, s57, s53
    s_lshr_b32 s54, s53, 2
    s_and_b32 s55, s53, 3
    s_lshl2_add_u32 s99, s55, s52
    s_lshl_b32 s99, s99, 10
    s_add_u32 s99, s99, s54
    s_lshl2_add_u32 s60, s53, s52
    s_lshl_b32 s60, s60, 7
    s_add_u32 s60, s60, s55
    s_movk_i32 s48, -512
    s_movk_i32 s49, 0x2120
    s_bitcmp1_b32 s2, 7
    s_cmovk_i32 s49, 0x510
    s_cselect_b32 s51, 12, 15
    s_cselect_b32 s43, 0, s43
    s_cselect_b32 s50, 12, 8
    s_cselect_b32 s60, s60, s99
    s_lshl_b32 s60, s60, 8
    s_lshl_b32 m0, s52, 13
    s_lshl_b32 s51, 1, s51
    s_lshl_b32 s38, 1, 24
    s_lshl_b32 s50, s50, 4
    v_mul_u32_u24 v16, s49, v3
    v_xor_b32 v208, v16, v4
    s_lshl_b32 s39, 1, 17
    s_bitcmp1_b32 s52, 0
    s_waitcnt lgkmcnt(0)
    s_cselect_b64 s[40:41], s[20:21], s[30:31]
    s_bitcmp1_b32 s2, 7
    s_cselect_b64 s[36:37], s[16:17], s[18:19]
    s_cselect_b64 s[40:41], s[40:41], s[14:15]
    s_load_dword s61, s[40:41], s43
L_first:
    s_and_b32 s49, s48, s50
    v_xor_b32 v16, s49, v208
    buffer_load_dwordx4 v16, s[36:39], s60 offen nt lds
    s_addk_i32 m0, 1024
    s_add_u32 s60, s60, s51
    s_add_u32 s48, s48, 64
    s_cbranch_scc0 L_first
    s_mov_b64 s[32:33], s[30:31]
    v_and_b32 v2, 15, v0
    s_mov_b32 s34, 0x10000000
    s_mov_b32 s35, 0x20000
    v_lshlrev_b32 v16, 1, v3
    v_xor_b32 v16, v16, v2
    v_lshlrev_b32 v6, 4, v16
    s_bitcmp1_b32 s2, 7
    s_cbranch_scc1 L_roleB
    v_xor_b32 v209, 0x80, v208
    s_lshl_b32 s99, s99, 8
    s_lshl_b32 s101, s52, 13
    s_add_u32 s101, s101, 0x18000
    s_mov_b32 s38, 0x400000
    s_and_b32 s57, s52, 2
    v_add_u32 v16, s57, v3
    v_lshlrev_b32 v17, 2, v16
    v_xor_b32 v17, v17, v2
    v_lshlrev_b32 v17, 4, v17
    v_lshl_add_u32 v232, v16, 10, v17
    s_lshl_b32 s57, s57, 8
    s_and_b32 s58, s52, 1
    s_lshl_b32 s58, s58, 10
    s_add_u32 s57, s57, s58
    s_add_u32 s18, s57, 151552
    s_lshl_b32 s19, s55, 8
    s_mov_b32 s46, 0x1000
    s_mov_b32 s47, 0x20000
    s_mov_b64 s[44:45], s[14:15]
    s_bitcmp1_b32 s52, 0
    s_cbranch_scc1 x_1
    s_mov_b32 m0, s18
    s_mov_b32 exec_hi, 0
    buffer_load_dwordx4 v232, s[44:47], s19 offen lds
    s_mov_b32 exec_hi, -1
x_1:
    s_load_dwordx8 s[4:11], s[0:1], 0
    s_load_dwordx2 s[12:13], s[0:1], 32
    s_xor_b32 s99, s99, 256
    v_lshlrev_b32 v90, 2, v2
    v_lshl_add_u32 v90, v3, 15, v90
    s_lshl2_add_u32 s98, s53, s52
    s_lshl_b32 s97, s98, 6
    s_xor_b32 s97, s97, 1024
    s_add_u32 s97, s97, 131072
    v_lshrrev_b32 v24, 1, v3
    v_xor_b32 v24, v24, v2
    v_lshlrev_b32 v24, 4, v24
    v_lshl_add_u32 v24, v3, 13, v24
    s_sub_u32 s100, s101, 0x8000
    v_lshrrev_b32 v16, 2, v2
    v_and_b32 v17, 1, v3
    v_lshl_or_b32 v17, v17, 2, v16
    v_lshlrev_b32 v17, 1, v17
    v_bfe_u32 v20, v1, 1, 1
    s_lshl_b32 s59, s52, 2
    v_or_b32 v20, s59, v20
    v_xor_b32 v17, v17, v20
    v_lshlrev_b32 v17, 4, v17
    v_and_b32 v21, 1, v1
    v_lshl_or_b32 v17, v21, 3, v17
    v_lshl_add_u32 v16, v3, 3, v16
    v_lshl_add_u32 v17, v16, 8, v17
    v_add_u32 v8, 0, v17
    v_xor_b32 v9, 32, v8
    s_mov_b32 s3, 0x3e0293ee
    v_xor_b32 v5, v3, v2
    v_lshlrev_b32 v5, 4, v5
    v_lshl_add_u32 v12, v2, 8, v5
    v_or_b32 v16, s59, v3
    v_and_b32 v17, 12, v2
    v_bfe_u32 v20, v1, 1, 1
    v_or_b32 v17, v17, v20
    v_xor_b32 v17, v17, v16
    v_lshlrev_b32 v17, 4, v17
    v_lshl_or_b32 v17, v21, 3, v17
    v_lshl_add_u32 v10, v16, 8, v17
    s_mov_b32 s62, 0x05040100
    s_mov_b32 s63, 0x07060302
    v_add_u32 v10, 131072, v10
    v_add_u32 v12, 131072, v12
    v_xor_b32 v11, 32, v10
    v_xor_b32 v13, 64, v12
    v_xor_b32 v14, 128, v12
    v_xor_b32 v15, 192, v12
    v_bfe_u32 v16, v1, 1, 1
    v_and_b32 v17, 12, v1
    v_lshlrev_b32 v17, 2, v17
    v_lshl_or_b32 v16, v16, 10, v17
    v_and_b32 v17, 1, v1
    v_lshl_or_b32 v88, v17, 3, v16
    v_lshl_add_u32 v89, v3, 13, v88
    v_lshl_add_u32 v88, v3, 11, v88
    v_lshl_add_u32 v216, v2, 9, v5
    v_add_u32 v216, s100, v216
    v_lshrrev_b32 v16, 2, v2
    v_mul_u32_u24 v16, 320, v16
    v_lshl_add_u32 v16, v3, 4, v16
    v_add_u32 v212, 0x20000, v16
    s_lshl_b32 s48, s53, 5
    v_mov_b32 v26, 65536
    v_lshlrev_b32 v228, 4, v2
    v_lshl_add_u32 v228, v3, 15, v228
    v_mov_b32 v224, -1
    v_mov_b32 v225, -1
    v_mov_b32 v226, -1
    v_mov_b32 v227, -1
    v_lshrrev_b32 v16, 2, v2
    v_and_b32 v17, 3, v1
    v_lshl_add_u32 v16, v16, 11, v17
    s_lshl2_add_u32 s57, s98, 2048
    v_add_lshl_u32 v220, v16, s57, 7
    s_lshl4_add_u32 s57, s98, 8192
    v_writelane_b32 v220, s57, 12
    s_getreg_b32 s16, hwreg(HW_REG_XCC_ID, 0, 4)
    s_lshl2_add_u32 s57, s55, s52
    s_lshl_b32 s57, s57, 6
    s_lshl_b32 s96, s54, 13
    s_add_u32 s96, s96, s57
    s_add_u32 s96, s96, 262144
    s_lshr_b32 s58, s54, 2
    s_and_b32 s59, s54, 3
    s_lshl4_add_u32 s98, s58, s59
    s_lshl_b32 s98, s98, 11
    s_add_u32 s98, s98, s57
    s_add_u32 s98, s98, 524288
    s_xor_b32 s98, s98, 4096
    s_lshl2_add_u32 s49, s54, s52
    s_lshl_b32 s49, s49, 11
    s_add_u32 s49, s49, 262144
    s_xor_b32 s49, s49, 8192
    v_xor_b32 v217, 64, v216
    v_xor_b32 v213, 64, v212
    v_xor_b32 v218, 128, v216
    v_xor_b32 v214, 128, v212
    v_xor_b32 v219, 192, v216
    v_xor_b32 v215, 192, v212
    s_load_dword s56, s[30:31], 0
    s_mov_b64 s[40:41], s[20:21]
    s_mov_b32 s42, 0x400000
    s_mov_b32 s43, 0x20000
    s_cmp_eq_u32 s52, 0
    s_cselect_b64 exec, -1, 0
    s_cbranch_execz L_nopoi
    buffer_store_dwordx4 v[224:227], v228, s[32:35], s97 offen sc1
L_nopoi:
    s_mov_b64 exec, 15
    buffer_load_dword v255, v220, s[32:35], 0 offen nt
    buffer_load_dword v255, v220, s[32:35], 0 offen sc1
    s_mov_b64 exec, -1
    s_add_u32 m0, s100, 0
    s_add_u32 s60, s99, 0
    v_xor_b32 v25, 0, v24
    buffer_load_dwordx4 v25, s[40:43], s60 offen nt lds
    s_add_u32 m0, s100, 1024
    s_add_u32 s60, s99, 32768
    v_xor_b32 v25, 32, v24
    buffer_load_dwordx4 v25, s[40:43], s60 offen nt lds
    s_add_u32 m0, s100, 2048
    s_add_u32 s60, s99, 65536
    v_xor_b32 v25, 64, v24
    buffer_load_dwordx4 v25, s[40:43], s60 offen nt lds
    s_add_u32 m0, s100, 3072
    s_add_u32 s60, s99, 98304
    v_xor_b32 v25, 96, v24
    buffer_load_dwordx4 v25, s[40:43], s60 offen nt lds
    s_add_u32 m0, s100, 4096
    s_add_u32 s60, s99, 131072
    v_xor_b32 v25, 128, v24
    buffer_load_dwordx4 v25, s[40:43], s60 offen nt lds
    s_add_u32 m0, s100, 5120
    s_add_u32 s60, s99, 163840
    v_xor_b32 v25, 160, v24
    buffer_load_dwordx4 v25, s[40:43], s60 offen nt lds
    s_add_u32 m0, s100, 6144
    s_add_u32 s60, s99, 196608
    v_xor_b32 v25, 192, v24
    buffer_load_dwordx4 v25, s[40:43], s60 offen nt lds
    s_add_u32 m0, s100, 7168
    s_add_u32 s60, s99, 229376
    v_xor_b32 v25, 224, v24
    buffer_load_dwordx4 v25, s[40:43], s60 offen nt lds
    s_waitcnt lgkmcnt(0)
    s_mov_b32 s61, 0
    s_add_u32 s56, s56, 0x9e3779b1
    s_xor_b32 s16, s16, s56
    v_mov_b32 v93, s16
    s_cmp_eq_u32 s52, 0
    s_cbranch_scc1 L_w0
    s_waitcnt vmcnt(10)
L_w0:
    s_waitcnt vmcnt(11)
    s_barrier
    ds_read_b128 v[32:35], v212 offset:20480
    ds_read_b64_tr_b16 v[48:49], v8 offset:0
    ds_read_b64_tr_b16 v[50:51], v8 offset:1024
    ds_read_b64_tr_b16 v[52:53], v9 offset:0
    ds_read_b64_tr_b16 v[54:55], v9 offset:1024
    ds_read_b128 v[36:39], v213 offset:20480
    ds_read_b64_tr_b16 v[56:57], v8 offset:8192
    ds_read_b64_tr_b16 v[58:59], v8 offset:9216
    ds_read_b64_tr_b16 v[60:61], v9 offset:8192
    ds_read_b64_tr_b16 v[62:63], v9 offset:9216
    ds_read_b128 v[40:43], v214 offset:20480
    ds_read_b64_tr_b16 v[64:65], v8 offset:16384
    ds_read_b64_tr_b16 v[66:67], v8 offset:17408
    ds_read_b64_tr_b16 v[68:69], v9 offset:16384
    ds_read_b64_tr_b16 v[70:71], v9 offset:17408
    ds_read_b128 v[44:47], v215 offset:20480
    ds_read_b64_tr_b16 v[72:73], v8 offset:24576
    ds_read_b64_tr_b16 v[74:75], v8 offset:25600
    ds_read_b64_tr_b16 v[76:77], v9 offset:24576
    ds_read_b64_tr_b16 v[78:79], v9 offset:25600
    v_add_u32 v8, 0x10000, v8
    v_add_u32 v9, 0x10000, v9
    s_waitcnt lgkmcnt(15)
    v_mfma_f32_16x16x32_bf16 v[80:83], v[32:35], v[48:51], 0
    v_mfma_f32_16x16x32_bf16 v[84:87], v[32:35], v[52:55], 0
    s_waitcnt lgkmcnt(10)
    v_mfma_f32_16x16x32_bf16 v[80:83], v[36:39], v[56:59], v[80:83]
    v_mfma_f32_16x16x32_bf16 v[84:87], v[36:39], v[60:63], v[84:87]
    s_waitcnt lgkmcnt(5)
    v_mfma_f32_16x16x32_bf16 v[80:83], v[40:43], v[64:67], v[80:83]
    v_mfma_f32_16x16x32_bf16 v[84:87], v[40:43], v[68:71], v[84:87]
    s_waitcnt lgkmcnt(0)
    v_mfma_f32_16x16x32_bf16 v[80:83], v[44:47], v[72:75], v[80:83]
    v_mfma_f32_16x16x32_bf16 v[84:87], v[44:47], v[76:79], v[84:87]
    s_nop 7
    v_cvt_pk_bf16_f32 v92, v80, v84
    buffer_store_dwordx2 v[92:93], v88, s[32:35], s96 offen
    s_add_u32 s96, s96, 1572864
    s_cmp_lg_u32 s52, 0
    s_cbranch_scc1 L_noflag
    s_mov_b64 exec, 1
    s_waitcnt vmcnt(11)
    buffer_store_dword v93, v26, s[32:35], s48 offen sc1
    s_mov_b64 exec, -1
    s_waitcnt vmcnt(2)
    s_branch L_flag
L_noflag:
    s_waitcnt vmcnt(1)
L_flag:
    buffer_load_dwordx4 v[224:227], v4, s[32:35], s49 offen offset:0 sc1
    buffer_load_dwordx4 v[228:231], v4, s[32:35], s49 offen offset:1024 sc1
    ds_read_b128 v[96:99], v216 offset:0
    ds_read_b128 v[100:103], v216 offset:256
    ds_read_b128 v[104:107], v217 offset:0
    ds_read_b128 v[108:111], v217 offset:256
    ds_read_b128 v[112:115], v218 offset:0
    ds_read_b128 v[116:119], v218 offset:256
    ds_read_b128 v[120:123], v219 offset:0
    ds_read_b128 v[124:127], v219 offset:256
    s_mov_b64 s[36:37], s[10:11]
    s_xor_b32 s99, s99, 768
    s_lshl3_add_u32 s57, s59, s58
    s_lshl4_add_u32 s57, s57, s55
    s_add_u32 s57, s57, 12
    s_lshl_b32 s100, s57, 16
    s_lshl_b32 s50, s52, 14
    s_add_u32 s51, s100, s50
    s_lshl_b32 s57, s55, 12
    s_add_u32 s51, s51, s57
    s_mov_b64 s[40:41], s[8:9]
    s_mov_b32 s42, 0x2000000
    s_mov_b32 s43, 0x20000
    s_waitcnt vmcnt(0)
    s_branch rcv_3
rcv_2:
    s_and_b32 s60, s61, 31
    s_cbranch_scc1 rcv_4
    buffer_store_dwordx2 v[92:93], v88, s[32:35], s96 offen sc1
rcv_4:
    s_cmp_lt_u32 s61, 64
    s_cselect_b32 s60, 0, s61
    s_bitcmp1_b32 s60, 0
    s_cselect_b32 s60, 1572864, 0
    s_add_u32 s60, s60, s49
    s_mov_b64 exec, vcc
    buffer_load_dwordx4 v[224:227], v4, s[32:35], s60 offen offset:0 sc1
    buffer_load_dwordx4 v[228:231], v4, s[32:35], s60 offen offset:1024 sc1
    s_mov_b64 exec, -1
    s_waitcnt vmcnt(0)
rcv_3:
    v_bitop3_b32 v16, v225, v227, s16 bitop3:0x7e
    v_bitop3_b32 v16, v16, v229, s16 bitop3:0xf6
    v_bitop3_b32 v16, v16, v231, s16 bitop3:0xf6
    v_cmp_ne_u32 vcc, 0, v16
    s_cbranch_vccz rcv_5
    v_cmp_lt_u32 vcc, 15, v16
    s_cbranch_vccz ok_6
    s_add_u32 s61, s61, 1
    s_cmp_lt_u32 s61, 200000
    s_cbranch_scc1 rcv_2
ok_6:
    buffer_store_dwordx2 v[92:93], v88, s[32:35], s96 offen sc1
rcv_5:
    v_perm_b32 v16, v226, v224, s62
    v_perm_b32 v17, v230, v228, s62
    v_perm_b32 v18, v226, v224, s63
    v_perm_b32 v19, v230, v228, s63
    ds_write_b64 v10, v[16:17] offset:0
    ds_write_b64 v11, v[18:19] offset:0
    s_waitcnt lgkmcnt(0)
    s_barrier
    ds_read_b128 v[32:35], v12 offset:0
    ds_read_b128 v[36:39], v13 offset:0
    ds_read_b128 v[40:43], v14 offset:0
    ds_read_b128 v[44:47], v15 offset:0
    s_waitcnt lgkmcnt(3)
    v_mfma_f32_16x16x32_bf16 v[80:83], v[32:35], v[96:99], 0
    v_mfma_f32_16x16x32_bf16 v[84:87], v[32:35], v[100:103], 0
    s_waitcnt lgkmcnt(2)
    v_mfma_f32_16x16x32_bf16 v[80:83], v[36:39], v[104:107], v[80:83]
    v_mfma_f32_16x16x32_bf16 v[84:87], v[36:39], v[108:111], v[84:87]
    s_waitcnt lgkmcnt(1)
    v_mfma_f32_16x16x32_bf16 v[80:83], v[40:43], v[112:115], v[80:83]
    v_mfma_f32_16x16x32_bf16 v[84:87], v[40:43], v[116:119], v[84:87]
    s_waitcnt lgkmcnt(0)
    v_mfma_f32_16x16x32_bf16 v[80:83], v[44:47], v[120:123], v[80:83]
    v_mfma_f32_16x16x32_bf16 v[84:87], v[44:47], v[124:127], v[84:87]
    s_nop 6
    v_add_f32 v80, v80, v81
    v_add_f32 v82, v82, v83
    v_add_f32 v84, v84, v85
    v_add_f32 v86, v86, v87
    v_add_f32 v18, v80, v82
    v_add_f32 v19, v84, v86
    v_cvt_pk_bf16_f32 v20, v18, v19
    s_nop 1
    v_mov_b32_dpp v21, v20 quad_perm:[1,1,1,1] row_mask:0xf bank_mask:0xf
    v_mov_b32_dpp v22, v20 quad_perm:[2,2,2,2] row_mask:0xf bank_mask:0xf
    v_mov_b32_dpp v23, v20 quad_perm:[3,3,3,3] row_mask:0xf bank_mask:0xf
    s_mov_b32 exec_lo, 0x11111111
    s_mov_b32 exec_hi, 0x11111111
    buffer_store_dwordx4 v[20:23], v90, s[32:35], s97 offen sc1
    s_mov_b64 exec, -1
    s_xor_b32 s49, s49, 8192
    s_add_u32 s49, s49, 262144
    s_mov_b64 s[44:45], s[4:5]
    s_bitcmp0_b32 s52, 0
    s_cbranch_scc1 x_7
    s_mov_b32 m0, s18
    s_mov_b32 exec_hi, 0
    buffer_load_dwordx4 v232, s[44:47], s19 offen lds
    s_mov_b32 exec_hi, -1
x_7:
    s_mov_b64 s[44:45], s[6:7]
    s_mov_b32 s46, 0x2000000
    s_mov_b32 s47, 0x20000
    v_mov_b32 v93, s56
    s_mov_b64 exec, 8176
    buffer_load_dword v255, v220, s[32:35], 0 offen nt
    buffer_load_dword v255, v220, s[32:35], 0 offen sc1
    s_mov_b64 exec, -1
    s_add_u32 m0, s101, 0
    s_add_u32 s60, s99, 0
    buffer_load_dwordx4 v208, s[36:39], s60 offen nt lds
    s_add_u32 m0, s101, 1024
    s_add_u32 s60, s99, 32768
    buffer_load_dwordx4 v208, s[36:39], s60 offen nt lds
    s_add_u32 m0, s101, 2048
    s_add_u32 s60, s99, 65536
    buffer_load_dwordx4 v209, s[36:39], s60 offen nt lds
    s_add_u32 m0, s101, 3072
    s_add_u32 s60, s99, 98304
    buffer_load_dwordx4 v209, s[36:39], s60 offen nt lds
    s_add_u32 m0, s101, 4096
    s_add_u32 s60, s99, 131072
    buffer_load_dwordx4 v208, s[36:39], s60 offen nt lds
    s_add_u32 m0, s101, 5120
    s_add_u32 s60, s99, 163840
    buffer_load_dwordx4 v208, s[36:39], s60 offen nt lds
    s_add_u32 m0, s101, 6144
    s_add_u32 s60, s99, 196608
    buffer_load_dwordx4 v209, s[36:39], s60 offen nt lds
    s_add_u32 m0, s101, 7168
    s_add_u32 s60, s99, 229376
    buffer_load_dwordx4 v209, s[36:39], s60 offen nt lds
    v_lshl_add_u32 v210, v3, 8, v6
    v_xor_b32 v211, 0x80, v210
    v_lshl_add_u32 v6, v3, 10, v6
    v_or_b32 v6, 0x0, v6
    v_xor_b32 v7, 0x80, v6
    v_lshl_add_u32 v216, v2, 10, v5
    v_add_u32 v216, s50, v216
    v_xor_b32 v217, 64, v216
    v_xor_b32 v218, 128, v216
    v_xor_b32 v219, 192, v216
    s_add_u32 m0, s50, 0
    s_xor_b32 s60, s51, 0
    v_xor_b32 v18, 0, v4
    buffer_load_dwordx4 v18, s[44:47], s60 offen offset:0 nt lds
    v_xor_b32 v19, 16, v4
    buffer_load_dwordx4 v19, s[44:47], s60 offen offset:1024 nt lds
    v_xor_b32 v18, 32, v4
    buffer_load_dwordx4 v18, s[44:47], s60 offen offset:2048 nt lds
    v_xor_b32 v19, 48, v4
    buffer_load_dwordx4 v19, s[44:47], s60 offen offset:3072 nt lds
    s_add_u32 m0, s50, 4096
    s_xor_b32 s60, s51, 4096
    v_xor_b32 v18, 64, v4
    buffer_load_dwordx4 v18, s[44:47], s60 offen offset:0 nt lds
    v_xor_b32 v19, 80, v4
    buffer_load_dwordx4 v19, s[44:47], s60 offen offset:1024 nt lds
    v_xor_b32 v18, 96, v4
    buffer_load_dwordx4 v18, s[44:47], s60 offen offset:2048 nt lds
    v_xor_b32 v19, 112, v4
    buffer_load_dwordx4 v19, s[44:47], s60 offen offset:3072 nt lds
    s_waitcnt vmcnt(8)
    s_barrier
    ds_read_b128 v[32:35], v212 offset:21504
    ds_read_b64_tr_b16 v[48:49], v8 offset:32768
    ds_read_b64_tr_b16 v[50:51], v8 offset:33792
    ds_read_b64_tr_b16 v[52:53], v9 offset:32768
    ds_read_b64_tr_b16 v[54:55], v9 offset:33792
    ds_read_b128 v[36:39], v213 offset:21504
    ds_read_b64_tr_b16 v[56:57], v8 offset:40960
    ds_read_b64_tr_b16 v[58:59], v8 offset:41984
    ds_read_b64_tr_b16 v[60:61], v9 offset:40960
    ds_read_b64_tr_b16 v[62:63], v9 offset:41984
    ds_read_b128 v[40:43], v214 offset:21504
    ds_read_b64_tr_b16 v[64:65], v8 offset:49152
    ds_read_b64_tr_b16 v[66:67], v8 offset:50176
    ds_read_b64_tr_b16 v[68:69], v9 offset:49152
    ds_read_b64_tr_b16 v[70:71], v9 offset:50176
    ds_read_b128 v[44:47], v215 offset:21504
    ds_read_b64_tr_b16 v[72:73], v8 offset:57344
    ds_read_b64_tr_b16 v[74:75], v8 offset:58368
    ds_read_b64_tr_b16 v[76:77], v9 offset:57344
    ds_read_b64_tr_b16 v[78:79], v9 offset:58368
    s_waitcnt lgkmcnt(15)
    v_mfma_f32_16x16x32_bf16 v[80:83], v[32:35], v[48:51], 0
    v_mfma_f32_16x16x32_bf16 v[84:87], v[32:35], v[52:55], 0
    s_waitcnt lgkmcnt(10)
    v_mfma_f32_16x16x32_bf16 v[80:83], v[36:39], v[56:59], v[80:83]
    v_mfma_f32_16x16x32_bf16 v[84:87], v[36:39], v[60:63], v[84:87]
    s_waitcnt lgkmcnt(5)
    v_mfma_f32_16x16x32_bf16 v[80:83], v[40:43], v[64:67], v[80:83]
    v_mfma_f32_16x16x32_bf16 v[84:87], v[40:43], v[68:71], v[84:87]
    s_waitcnt lgkmcnt(0)
    v_mfma_f32_16x16x32_bf16 v[80:83], v[44:47], v[72:75], v[80:83]
    v_mfma_f32_16x16x32_bf16 v[84:87], v[44:47], v[76:79], v[84:87]
    s_nop 7
    v_cvt_pk_bf16_f32 v92, v80, v84
    buffer_store_dwordx2 v[92:93], v89, s[32:35], s98 offen
    s_add_u32 s98, s98, 6553600
    s_barrier
    s_add_u32 m0, s50, 8192
    s_xor_b32 s60, s51, 8192
    v_xor_b32 v18, 128, v4
    buffer_load_dwordx4 v18, s[44:47], s60 offen offset:0 nt lds
    v_xor_b32 v19, 144, v4
    buffer_load_dwordx4 v19, s[44:47], s60 offen offset:1024 nt lds
    v_xor_b32 v18, 160, v4
    buffer_load_dwordx4 v18, s[44:47], s60 offen offset:2048 nt lds
    v_xor_b32 v19, 176, v4
    buffer_load_dwordx4 v19, s[44:47], s60 offen offset:3072 nt lds
    s_add_u32 m0, s50, 12288
    s_xor_b32 s60, s51, 12288
    v_xor_b32 v18, 192, v4
    buffer_load_dwordx4 v18, s[44:47], s60 offen offset:0 nt lds
    v_xor_b32 v19, 208, v4
    buffer_load_dwordx4 v19, s[44:47], s60 offen offset:1024 nt lds
    v_xor_b32 v18, 224, v4
    buffer_load_dwordx4 v18, s[44:47], s60 offen offset:2048 nt lds
    v_xor_b32 v19, 240, v4
    buffer_load_dwordx4 v19, s[44:47], s60 offen offset:3072 nt lds
    s_mov_b64 s[36:37], s[12:13]
    s_and_b32 s96, s54, 28
    s_or_b32 s96, s96, s55
    s_and_b32 s97, s54, 3
    s_xor_b32 s97, s97, 3
    s_lshl2_add_u32 s99, s96, s52
    s_lshl_b32 s99, s99, 7
    s_add_u32 s99, s99, s97
    s_lshl_b32 s99, s99, 8
    s_lshl_b32 s101, s52, 13
    s_and_b32 s48, s53, 0x70
    v_add_lshl_u32 v233, v2, s48, 4
    v_add_u32 v233, 32768, v233
    s_mov_b32 exec_lo, 0
    v_lshlrev_b32 v233, 1, v233
    s_mov_b32 exec_lo, -1
    s_lshl2_add_u32 s24, s96, s52
    s_lshl_b32 s24, s24, 11
    s_add_u32 s24, s24, 786432
    v_and_b32 v221, 3, v1
    v_lshl_add_u32 v221, v3, 2, v221
    v_lshlrev_b32 v221, 4, v221
    s_lshl_b32 s25, s96, 8
    s_add_u32 s25, s25, 8192
    s_add_u32 m0, s101, 65536
    s_xor_b32 s60, s51, 0
    buffer_load_dwordx4 v210, s[40:43], s60 offen offset:0 nt lds
    buffer_load_dwordx4 v210, s[40:43], s60 offen offset:1024 nt lds
    buffer_load_dwordx4 v211, s[40:43], s60 offen offset:2048 nt lds
    buffer_load_dwordx4 v211, s[40:43], s60 offen offset:3072 nt lds
    buffer_load_dwordx4 v[224:227], v4, s[32:35], s49 offen offset:0 sc1
    buffer_load_dwordx4 v[228:231], v4, s[32:35], s49 offen offset:1024 sc1
    buffer_load_dword v232, v233, s[32:35], 0 offen sc1
    s_add_u32 m0, s101, 69632
    s_xor_b32 s60, s51, 4096
    buffer_load_dwordx4 v210, s[40:43], s60 offen offset:0 nt lds
    buffer_load_dwordx4 v210, s[40:43], s60 offen offset:1024 nt lds
    buffer_load_dwordx4 v211, s[40:43], s60 offen offset:2048 nt lds
    buffer_load_dwordx4 v211, s[40:43], s60 offen offset:3072 nt lds
    s_waitcnt vmcnt(11)
    ds_read_b128 v[128:131], v216 offset:0
    ds_read_b128 v[132:135], v217 offset:0
    ds_read_b128 v[136:139], v218 offset:0
    ds_read_b128 v[140:143], v219 offset:0
    ds_read_b128 v[144:147], v216 offset:256
    ds_read_b128 v[148:151], v217 offset:256
    ds_read_b128 v[152:155], v218 offset:256
    ds_read_b128 v[156:159], v219 offset:256
    ds_read_b128 v[160:163], v216 offset:512
    ds_read_b128 v[164:167], v217 offset:512
    ds_read_b128 v[168:171], v218 offset:512
    ds_read_b128 v[172:175], v219 offset:512
    ds_read_b128 v[176:179], v216 offset:768
    ds_read_b128 v[180:183], v217 offset:768
    ds_read_b128 v[184:187], v218 offset:768
    ds_read_b128 v[188:191], v219 offset:768
    s_add_u32 m0, s101, 98304
    s_xor_b32 s60, s51, 8192
    buffer_load_dwordx4 v210, s[40:43], s60 offen offset:0 nt lds
    buffer_load_dwordx4 v210, s[40:43], s60 offen offset:1024 nt lds
    buffer_load_dwordx4 v211, s[40:43], s60 offen offset:2048 nt lds
    buffer_load_dwordx4 v211, s[40:43], s60 offen offset:3072 nt lds
    v_lshlrev_b32 v91, 3, v2
    v_lshl_add_u32 v91, v3, 14, v91
    s_lshl4_add_u32 s100, s97, s52
    s_lshl_b32 s100, s100, 5
    s_add_u32 s100, s100, s96
    s_lshl_b32 s100, s100, 7
    s_add_u32 s100, s100, 1310720
    s_mov_b32 s28, 0x07060500
    s_mov_b32 s29, 0x07060501
    s_lshl_b32 s59, s52, 2
    s_add_u32 s59, s59, 0x20000
    v_lshlrev_b32 v24, 4, v3
    v_add_u32 v25, s59, v24
    v_add_u32 v24, 0x20000, v24
    s_lshl_b32 s59, s52, 7
    s_add_u32 s59, s59, 0x20000
    v_mul_u32_u24 v26, 576, v3
    v_lshl_add_u32 v26, v2, 3, v26
    v_add_u32 v26, s59, v26
    v_lshrrev_b32 v27, 2, v2
    v_mul_u32_u24 v27, 576, v27
    v_add_u32 v27, v27, v24
    s_waitcnt lgkmcnt(0)
    s_waitcnt vmcnt(8)
    s_branch rcv_9
rcv_8:
    s_and_b32 s60, s61, 31
    s_cbranch_scc1 rcv_10
    buffer_store_dwordx2 v[92:93], v89, s[32:35], s98 offen sc1
rcv_10:
    s_cmp_lt_u32 s61, 64
    s_cselect_b32 s60, 0, s61
    s_bitcmp1_b32 s60, 0
    s_cselect_b32 s60, 6553600, 0
    s_add_u32 s60, s60, s49
    s_mov_b64 exec, vcc
    buffer_load_dwordx4 v[224:227], v4, s[32:35], s60 offen offset:0 sc1
    buffer_load_dwordx4 v[228:231], v4, s[32:35], s60 offen offset:1024 sc1
    s_mov_b64 exec, -1
    buffer_load_dword v232, v233, s[32:35], 0 offen sc1
    s_waitcnt vmcnt(0)
rcv_9:
    v_bitop3_b32 v16, v225, v227, s56 bitop3:0x7e
    v_bitop3_b32 v16, v16, v229, s56 bitop3:0xf6
    v_bitop3_b32 v16, v16, v231, s56 bitop3:0xf6
    v_cmp_ne_u32 vcc, 0, v16
    s_cbranch_vccz ok_11
    s_add_u32 s61, s61, 1
    s_cmp_lt_u32 s61, 200000
    s_cbranch_scc1 rcv_8
ok_11:
    v_perm_b32 v16, v226, v224, s62
    v_perm_b32 v17, v230, v228, s62
    v_perm_b32 v18, v226, v224, s63
    v_perm_b32 v19, v230, v228, s63
    ds_write_b64 v10, v[16:17] offset:4096
    ds_write_b64 v11, v[18:19] offset:4096
    v_cmp_ne_u32 vcc, s16, v232
    s_nop 0
    s_cmp_eq_u64 vcc, 0
    s_cselect_b32 s17, 1, 0
    s_cmp_eq_u32 s17, 0
    s_cbranch_scc1 slow_12
back_13:
    s_add_u32 m0, s101, 102400
    s_xor_b32 s60, s51, 12288
    buffer_load_dwordx4 v210, s[40:43], s60 offen offset:0 nt lds
    buffer_load_dwordx4 v210, s[40:43], s60 offen offset:1024 nt lds
    buffer_load_dwordx4 v211, s[40:43], s60 offen offset:2048 nt lds
    buffer_load_dwordx4 v211, s[40:43], s60 offen offset:3072 nt lds
    s_add_u32 m0, s50, 8192
    s_add_u32 s60, s99, 0
    buffer_load_dwordx4 v6, s[36:39], s60 offen nt lds
    s_waitcnt lgkmcnt(0)
    s_barrier
    ds_read_b128 v[32:35], v12 offset:4096
    ds_read_b128 v[36:39], v13 offset:4096
    ds_read_b128 v[40:43], v14 offset:4096
    ds_read_b128 v[44:47], v15 offset:4096
    s_waitcnt lgkmcnt(3)
    v_mfma_f32_16x16x32_bf16 v[192:195], v[32:35], v[128:131], 0
    v_mfma_f32_16x16x32_bf16 v[196:199], v[32:35], v[144:147], 0
    v_mfma_f32_16x16x32_bf16 v[200:203], v[32:35], v[160:163], 0
    v_mfma_f32_16x16x32_bf16 v[204:207], v[32:35], v[176:179], 0
    s_waitcnt lgkmcnt(2)
    v_mfma_f32_16x16x32_bf16 v[192:195], v[36:39], v[132:135], v[192:195]
    v_mfma_f32_16x16x32_bf16 v[196:199], v[36:39], v[148:151], v[196:199]
    v_mfma_f32_16x16x32_bf16 v[200:203], v[36:39], v[164:167], v[200:203]
    v_mfma_f32_16x16x32_bf16 v[204:207], v[36:39], v[180:183], v[204:207]
    s_waitcnt lgkmcnt(1)
    v_mfma_f32_16x16x32_bf16 v[192:195], v[40:43], v[136:139], v[192:195]
    v_mfma_f32_16x16x32_bf16 v[196:199], v[40:43], v[152:155], v[196:199]
    v_mfma_f32_16x16x32_bf16 v[200:203], v[40:43], v[168:171], v[200:203]
    v_mfma_f32_16x16x32_bf16 v[204:207], v[40:43], v[184:187], v[204:207]
    s_waitcnt lgkmcnt(0)
    v_mfma_f32_16x16x32_bf16 v[192:195], v[44:47], v[140:143], v[192:195]
    v_mfma_f32_16x16x32_bf16 v[196:199], v[44:47], v[156:159], v[196:199]
    v_mfma_f32_16x16x32_bf16 v[200:203], v[44:47], v[172:175], v[200:203]
    v_mfma_f32_16x16x32_bf16 v[204:207], v[44:47], v[188:191], v[204:207]
    s_add_u32 m0, s50, 9216
    s_add_u32 s60, s99, 4096
    buffer_load_dwordx4 v6, s[36:39], s60 offen nt lds
    s_add_u32 m0, s50, 10240
    s_add_u32 s60, s99, 8192
    buffer_load_dwordx4 v7, s[36:39], s60 offen nt lds
    v_add_f32 v192, v192, v193
    v_add_f32 v194, v194, v195
    v_add_f32 v196, v196, v197
    v_add_f32 v198, v198, v199
    v_add_f32 v200, v200, v201
    v_add_f32 v202, v202, v203
    v_add_f32 v204, v204, v205
    v_add_f32 v206, v206, v207
    v_add_f32 v16, v192, v194
    v_add_f32 v17, v196, v198
    v_add_f32 v18, v200, v202
    v_add_f32 v19, v204, v206
    v_max_f32 v20, v16, v17
    v_max3_f32 v20, v20, v18, v19
    s_nop 1
    v_max_f32_dpp v20, v20, v20 row_ror:8 row_mask:0xf bank_mask:0xf
    s_nop 1
    v_max_f32_dpp v20, v20, v20 row_ror:4 row_mask:0xf bank_mask:0xf
    s_nop 1
    v_max_f32_dpp v20, v20, v20 row_ror:2 row_mask:0xf bank_mask:0xf
    s_nop 1
    v_max_f32_dpp v20, v20, v20 row_ror:1 row_mask:0xf bank_mask:0xf
    ds_write_b32 v25, v20 offset:16384
    s_add_u32 m0, s50, 11264
    s_add_u32 s60, s99, 12288
    buffer_load_dwordx4 v7, s[36:39], s60 offen nt lds
    s_add_u32 m0, s50, 12288
    s_add_u32 s60, s99, 16384
    buffer_load_dwordx4 v6, s[36:39], s60 offen nt lds
    s_waitcnt lgkmcnt(0)
    s_barrier
    ds_read_b128 v[28:31], v24 offset:16384
    s_add_u32 m0, s50, 13312
    s_add_u32 s60, s99, 20480
    buffer_load_dwordx4 v6, s[36:39], s60 offen nt lds
    s_add_u32 m0, s50, 14336
    s_add_u32 s60, s99, 24576
    buffer_load_dwordx4 v7, s[36:39], s60 offen nt lds
    s_waitcnt lgkmcnt(0)
    v_max_f32 v20, v28, v29
    v_max3_f32 v20, v20, v30, v31
    v_mul_f32 v20, s3, v20
    v_fma_f32 v16, v16, s3, -v20
    v_fma_f32 v17, v17, s3, -v20
    v_fma_f32 v18, v18, s3, -v20
    v_fma_f32 v19, v19, s3, -v20
    v_exp_f32 v16, v16
    v_exp_f32 v17, v17
    v_exp_f32 v18, v18
    v_exp_f32 v19, v19
    v_cvt_pk_bf16_f32 v28, v16, v17
    v_cvt_pk_bf16_f32 v29, v18, v19
    ds_write_b64 v26, v[28:29] offset:16640
    v_add_f32 v16, v16, v17
    v_add_f32 v18, v18, v19
    v_add_f32 v16, v16, v18
    s_nop 1
    v_add_f32_dpp v16, v16, v16 row_ror:8 row_mask:0xf bank_mask:0xf
    s_nop 1
    v_add_f32_dpp v16, v16, v16 row_ror:4 row_mask:0xf bank_mask:0xf
    s_nop 1
    v_add_f32_dpp v16, v16, v16 row_ror:2 row_mask:0xf bank_mask:0xf
    s_nop 1
    v_add_f32_dpp v16, v16, v16 row_ror:1 row_mask:0xf bank_mask:0xf
    ds_write_b32 v25, v16 offset:16448
    s_add_u32 m0, s50, 15360
    s_add_u32 s60, s99, 28672
    buffer_load_dwordx4 v7, s[36:39], s60 offen nt lds
    s_waitcnt vmcnt(16) lgkmcnt(0)
    s_barrier
    ds_read_b128 v[96:99], v27 offset:16640
    ds_read_b128 v[100:103], v27 offset:16768
    ds_read_b128 v[104:107], v27 offset:16896
    ds_read_b128 v[108:111], v27 offset:17024
    ds_read_b128 v[112:115], v27 offset:16704
    ds_read_b128 v[116:119], v27 offset:16832
    ds_read_b128 v[120:123], v27 offset:16960
    ds_read_b128 v[124:127], v27 offset:17088
    ds_read_b128 v[28:31], v24 offset:16448
    ds_read_b64_tr_b16 v[48:49], v8 offset:0
    ds_read_b64_tr_b16 v[50:51], v8 offset:1024
    ds_read_b64_tr_b16 v[52:53], v9 offset:0
    ds_read_b64_tr_b16 v[54:55], v9 offset:1024
    ds_read_b64_tr_b16 v[56:57], v8 offset:8192
    ds_read_b64_tr_b16 v[58:59], v8 offset:9216
    ds_read_b64_tr_b16 v[60:61], v9 offset:8192
    ds_read_b64_tr_b16 v[62:63], v9 offset:9216
    ds_read_b64_tr_b16 v[64:65], v8 offset:16384
    ds_read_b64_tr_b16 v[66:67], v8 offset:17408
    ds_read_b64_tr_b16 v[68:69], v9 offset:16384
    ds_read_b64_tr_b16 v[70:71], v9 offset:17408
    ds_read_b64_tr_b16 v[72:73], v8 offset:24576
    ds_read_b64_tr_b16 v[74:75], v8 offset:25600
    ds_read_b64_tr_b16 v[76:77], v9 offset:24576
    ds_read_b64_tr_b16 v[78:79], v9 offset:25600
    s_waitcnt lgkmcnt(0)
    v_mfma_f32_16x16x32_bf16 v[80:83], v[96:99], v[48:51], 0
    v_mfma_f32_16x16x32_bf16 v[84:87], v[96:99], v[52:55], 0
    v_mfma_f32_16x16x32_bf16 v[80:83], v[100:103], v[56:59], v[80:83]
    v_mfma_f32_16x16x32_bf16 v[84:87], v[100:103], v[60:63], v[84:87]
    v_mfma_f32_16x16x32_bf16 v[80:83], v[104:107], v[64:67], v[80:83]
    v_mfma_f32_16x16x32_bf16 v[84:87], v[104:107], v[68:71], v[84:87]
    v_mfma_f32_16x16x32_bf16 v[80:83], v[108:111], v[72:75], v[80:83]
    v_mfma_f32_16x16x32_bf16 v[84:87], v[108:111], v[76:79], v[84:87]
    v_add_f32 v28, v28, v29
    v_add_f32 v30, v30, v31
    v_add_f32 v22, v28, v30
    v_mov_b32 v21, s56
    v_mov_b32 v23, s56
    s_lshr_b32 s57, s53, 4
    s_and_b32 s58, s53, 15
    s_lshl_b32 s57, s57, 6
    s_add_u32 s57, s57, s58
    s_lshl_b32 s57, s57, 4
    s_add_u32 s57, s57, 8192
    v_lshlrev_b32 v28, 8, v3
    s_xor_b32 s98, s98, 4096
    s_sub_u32 s98, s98, 6291456
    s_waitcnt vmcnt(8)
    s_barrier
    ds_read_b64_tr_b16 v[128:129], v8 offset:32768
    ds_read_b64_tr_b16 v[130:131], v8 offset:33792
    ds_read_b64_tr_b16 v[132:133], v9 offset:32768
    ds_read_b64_tr_b16 v[134:135], v9 offset:33792
    ds_read_b64_tr_b16 v[136:137], v8 offset:40960
    ds_read_b64_tr_b16 v[138:139], v8 offset:41984
    ds_read_b64_tr_b16 v[140:141], v9 offset:40960
    ds_read_b64_tr_b16 v[142:143], v9 offset:41984
    ds_read_b64_tr_b16 v[144:145], v8 offset:49152
    ds_read_b64_tr_b16 v[146:147], v8 offset:50176
    ds_read_b64_tr_b16 v[148:149], v9 offset:49152
    ds_read_b64_tr_b16 v[150:151], v9 offset:50176
    ds_read_b64_tr_b16 v[152:153], v8 offset:57344
    ds_read_b64_tr_b16 v[154:155], v8 offset:58368
    ds_read_b64_tr_b16 v[156:157], v9 offset:57344
    ds_read_b64_tr_b16 v[158:159], v9 offset:58368
    s_cmp_lg_u32 s52, 0
    s_cbranch_scc1 L_nostatA
    s_mov_b32 exec_lo, 0x00010001
    s_mov_b32 exec_hi, 0x00010001
    s_cmp_eq_u32 s17, 0
    s_cbranch_scc1 slow_14
    buffer_store_dwordx4 v[20:23], v28, s[32:35], s57 offen
back_15:
    s_mov_b64 exec, -1
    s_nop 3
L_nostatA:
    s_waitcnt lgkmcnt(12)
    v_mfma_f32_16x16x32_bf16 v[80:83], v[112:115], v[128:131], v[80:83]
    v_mfma_f32_16x16x32_bf16 v[84:87], v[112:115], v[132:135], v[84:87]
    s_waitcnt lgkmcnt(8)
    v_mfma_f32_16x16x32_bf16 v[80:83], v[116:119], v[136:139], v[80:83]
    v_mfma_f32_16x16x32_bf16 v[84:87], v[116:119], v[140:143], v[84:87]
    s_waitcnt lgkmcnt(4)
    v_mfma_f32_16x16x32_bf16 v[80:83], v[120:123], v[144:147], v[80:83]
    v_mfma_f32_16x16x32_bf16 v[84:87], v[120:123], v[148:151], v[84:87]
    s_waitcnt lgkmcnt(0)
    v_mfma_f32_16x16x32_bf16 v[80:83], v[124:127], v[152:155], v[80:83]
    v_mfma_f32_16x16x32_bf16 v[84:87], v[124:127], v[156:159], v[84:87]
    v_subrev_u32 v8, 0x10000, v8
    v_subrev_u32 v9, 0x10000, v9
    s_nop 5
    v_cvt_pk_bf16_f32 v92, v80, v84
    s_cmp_eq_u32 s17, 0
    s_cbranch_scc1 slow_16
    buffer_store_dwordx2 v[92:93], v89, s[32:35], s98 offen
back_17:
    s_waitcnt vmcnt(3)
    buffer_load_dwordx4 v[224:227], v4, s[32:35], s24 offen offset:0 sc1
    buffer_load_dwordx4 v[228:231], v4, s[32:35], s24 offen offset:1024 sc1
    buffer_load_dwordx4 v[240:243], v221, s[32:35], s25 offen sc1
    s_waitcnt vmcnt(3)
    s_barrier
    ds_read_b64_tr_b16 v[48:49], v8 offset:8192
    ds_read_b64_tr_b16 v[50:51], v8 offset:9216
    ds_read_b64_tr_b16 v[52:53], v9 offset:8192
    ds_read_b64_tr_b16 v[54:55], v9 offset:9216
    ds_read_b64_tr_b16 v[56:57], v8 offset:24576
    ds_read_b64_tr_b16 v[58:59], v8 offset:25600
    ds_read_b64_tr_b16 v[60:61], v9 offset:24576
    ds_read_b64_tr_b16 v[62:63], v9 offset:25600
    ds_read_b64_tr_b16 v[64:65], v8 offset:40960
    ds_read_b64_tr_b16 v[66:67], v8 offset:41984
    ds_read_b64_tr_b16 v[68:69], v9 offset:40960
    ds_read_b64_tr_b16 v[70:71], v9 offset:41984
    ds_read_b64_tr_b16 v[72:73], v8 offset:57344
    ds_read_b64_tr_b16 v[74:75], v8 offset:58368
    ds_read_b64_tr_b16 v[76:77], v9 offset:57344
    ds_read_b64_tr_b16 v[78:79], v9 offset:58368
    s_waitcnt vmcnt(0)
    s_branch rcv_19
rcv_18:
    buffer_load_dwordx4 v[224:227], v4, s[32:35], s24 offen offset:0 sc1
    buffer_load_dwordx4 v[228:231], v4, s[32:35], s24 offen offset:1024 sc1
    buffer_load_dwordx4 v[240:243], v221, s[32:35], s25 offen sc1
    s_waitcnt vmcnt(0)
rcv_19:
    v_bitop3_b32 v16, v225, v227, s56 bitop3:0x7e
    v_bitop3_b32 v16, v16, v229, s56 bitop3:0xf6
    v_bitop3_b32 v16, v16, v231, s56 bitop3:0xf6
    v_bitop3_b32 v16, v16, v241, s56 bitop3:0xf6
    v_bitop3_b32 v16, v16, v243, s56 bitop3:0xf6
    v_cmp_ne_u32 vcc, 0, v16
    s_cbranch_vccz ok_20
    s_add_u32 s61, s61, 1
    s_cmp_lt_u32 s61, 200000
    s_cbranch_scc1 rcv_18
ok_20:
    v_perm_b32 v16, v226, v224, s62
    v_perm_b32 v17, v230, v228, s62
    v_perm_b32 v18, v226, v224, s63
    v_perm_b32 v19, v230, v228, s63
    ds_write_b64 v10, v[16:17] offset:8192
    ds_write_b64 v11, v[18:19] offset:8192
    v_max_f32_dpp v24, v240, v240 quad_perm:[1,0,3,2] row_mask:0xf bank_mask:0xf
    s_nop 1
    v_max_f32_dpp v24, v24, v24 quad_perm:[2,3,0,1] row_mask:0xf bank_mask:0xf
    v_sub_f32 v24, v240, v24
    v_exp_f32 v24, v24
    s_nop 0
    v_mul_f32 v25, v24, v242
    s_nop 1
    v_add_f32_dpp v25, v25, v25 quad_perm:[1,0,3,2] row_mask:0xf bank_mask:0xf
    s_nop 1
    v_add_f32_dpp v25, v25, v25 quad_perm:[2,3,0,1] row_mask:0xf bank_mask:0xf
    v_rcp_f32 v25, v25
    s_nop 0
    v_mul_f32 v24, v24, v25
    s_waitcnt lgkmcnt(0)
    s_barrier
    ds_read_b128 v[32:35], v12 offset:8192
    ds_read_b128 v[36:39], v13 offset:8192
    ds_read_b128 v[40:43], v14 offset:8192
    ds_read_b128 v[44:47], v15 offset:8192
    s_waitcnt lgkmcnt(3)
    v_mfma_f32_16x16x32_bf16 v[80:83], v[32:35], v[48:51], 0
    v_mfma_f32_16x16x32_bf16 v[84:87], v[32:35], v[52:55], 0
    s_waitcnt lgkmcnt(2)
    v_mfma_f32_16x16x32_bf16 v[80:83], v[36:39], v[56:59], v[80:83]
    v_mfma_f32_16x16x32_bf16 v[84:87], v[36:39], v[60:63], v[84:87]
    s_waitcnt lgkmcnt(1)
    v_mfma_f32_16x16x32_bf16 v[80:83], v[40:43], v[64:67], v[80:83]
    v_mfma_f32_16x16x32_bf16 v[84:87], v[40:43], v[68:71], v[84:87]
    s_waitcnt lgkmcnt(0)
    v_mfma_f32_16x16x32_bf16 v[80:83], v[44:47], v[72:75], v[80:83]
    v_mfma_f32_16x16x32_bf16 v[84:87], v[44:47], v[76:79], v[84:87]
    s_nop 6
    v_mul_f32_dpp v16, v24, v80 quad_perm:[0,0,0,0] row_mask:0xf bank_mask:0xf
    v_mul_f32_dpp v17, v24, v84 quad_perm:[0,0,0,0] row_mask:0xf bank_mask:0xf
    s_nop 0
    v_fmac_f32_dpp v16, v24, v81 quad_perm:[1,1,1,1] row_mask:0xf bank_mask:0xf
    v_fmac_f32_dpp v17, v24, v85 quad_perm:[1,1,1,1] row_mask:0xf bank_mask:0xf
    s_nop 0
    v_fmac_f32_dpp v16, v24, v82 quad_perm:[2,2,2,2] row_mask:0xf bank_mask:0xf
    v_fmac_f32_dpp v17, v24, v86 quad_perm:[2,2,2,2] row_mask:0xf bank_mask:0xf
    s_nop 0
    v_fmac_f32_dpp v16, v24, v83 quad_perm:[3,3,3,3] row_mask:0xf bank_mask:0xf
    v_fmac_f32_dpp v17, v24, v87 quad_perm:[3,3,3,3] row_mask:0xf bank_mask:0xf
    v_perm_b32 v16, v16, v93, s28
    v_perm_b32 v17, v17, v93, s29
    buffer_store_dwordx2 v[16:17], v91, s[32:35], s100 offen sc1
    s_waitcnt vmcnt(0)
    s_barrier
    s_and_b32 s57, s53, 1
    s_or_b32 s57, s57, s52
    s_cmp_lg_u32 s57, 0
    s_cbranch_scc1 fin_21
    s_lshl_b32 s57, s53, 11
    s_add_u32 s57, s57, 1310720
    s_bfe_u32 s58, s53, 0x20003
    s_lshl1_add_u32 s58, s58, 0
    s_lshr_b32 s59, s53, 5
    s_lshl2_add_u32 s58, s58, s59
    s_bfe_u32 s59, s53, 0x20001
    s_lshl2_add_u32 s58, s58, s59
    s_lshl_b32 s58, s58, 6
    s_lshr_b32 s59, s56, 8
    v_and_b32 v89, 7, v1
    v_lshlrev_b32 v89, 2, v89
    v_and_or_b32 v89, v1, 32, v89
    s_mov_b64 s[48:49], s[26:27]
    s_mov_b32 s50, 0x2000
    s_mov_b32 s51, 0x20000
    s_waitcnt vmcnt(0)
    s_mov_b64 vcc, -1
red_22:
    s_mov_b64 exec, vcc
    buffer_load_dwordx4 v[32:35], v4, s[32:35], s57 offen offset:0 sc1
    buffer_load_dwordx4 v[36:39], v4, s[32:35], s57 offen offset:1024 sc1
    buffer_load_dwordx4 v[40:43], v4, s[32:35], s57 offen offset:2048 sc1
    buffer_load_dwordx4 v[44:47], v4, s[32:35], s57 offen offset:3072 sc1
    s_waitcnt vmcnt(2)
    v_bitop3_b32 v24, v32, v34, s56 bitop3:0x7e
    v_bitop3_b32 v25, v33, v35, s59 bitop3:0x7e
    v_bitop3_b32 v26, v36, v38, s56 bitop3:0x7e
    v_bitop3_b32 v27, v37, v39, s59 bitop3:0x7e
    v_or3_b32 v24, v24, v25, v26
    v_add_f32 v20, v32, v36
    v_add_f32 v21, v33, v37
    v_add_f32 v22, v34, v38
    v_add_f32 v23, v35, v39
    s_waitcnt vmcnt(0)
    v_bitop3_b32 v28, v40, v42, s56 bitop3:0x7e
    v_bitop3_b32 v29, v41, v43, s59 bitop3:0x7e
    v_bitop3_b32 v30, v44, v46, s56 bitop3:0x7e
    v_bitop3_b32 v31, v45, v47, s59 bitop3:0x7e
    v_or3_b32 v24, v24, v27, v28
    v_or3_b32 v29, v29, v30, v31
    v_or_b32 v24, v24, v29
    v_and_b32 v24, 0xff, v24
    v_cmp_ne_u32 vcc, 0, v24
    s_cbranch_vccz ok_23
    s_add_u32 s61, s61, 1
    s_cmp_lt_u32 s61, 200000
    s_cbranch_scc1 red_22
ok_23:
    s_mov_b64 exec, -1
    v_add_f32 v32, v40, v44
    v_add_f32 v33, v41, v45
    v_add_f32 v34, v42, v46
    v_add_f32 v35, v43, v47
    v_add_f32 v20, v20, v32
    v_add_f32 v21, v21, v33
    v_add_f32 v22, v22, v34
    v_add_f32 v23, v23, v35
    v_permlane32_swap_b32 v20, v21
    s_nop 0
    v_permlane32_swap_b32 v22, v23
    v_add_f32 v20, v20, v21
    v_add_f32 v22, v22, v23
    v_mov_b32 v21, v20
    v_mov_b32 v23, v22
    s_nop 0
    v_permlane16_swap_b32 v20, v21
    v_permlane16_swap_b32 v22, v23
    v_add_f32 v20, v20, v21
    v_add_f32 v22, v22, v23
    s_nop 0
    v_add_f32_dpp v20, v20, v20 row_ror:8 row_mask:0xf bank_mask:0xf
    v_add_f32_dpp v22, v22, v22 row_ror:8 row_mask:0xf bank_mask:0xf
    v_cvt_pk_bf16_f32 v20, v20, v22
    s_mov_b32 exec_lo, 0xff
    s_mov_b32 exec_hi, 0xff
    buffer_store_dword v20, v89, s[48:51], s58 offen
fin_21:
    s_endpgm
L_roleB:
    s_sub_u32 s49, s60, 32768
    v_xor_b32 v96, 0, v208
    v_xor_b32 v97, 64, v208
    v_xor_b32 v98, 128, v208
    v_xor_b32 v99, 192, v208
    v_lshrrev_b32 v16, 2, v2
    v_and_b32 v17, 1, v3
    v_lshl_or_b32 v17, v17, 2, v16
    v_lshlrev_b32 v17, 1, v17
    v_bfe_u32 v20, v1, 1, 1
    s_lshl_b32 s59, s52, 2
    v_or_b32 v20, s59, v20
    v_xor_b32 v17, v17, v20
    v_lshlrev_b32 v17, 4, v17
    v_and_b32 v21, 1, v1
    v_lshl_or_b32 v17, v21, 3, v17
    v_lshl_add_u32 v16, v3, 3, v16
    v_lshl_add_u32 v17, v16, 8, v17
    v_add_u32 v8, 32768, v17
    v_xor_b32 v9, 32, v8
    s_mov_b32 s3, 0x3e0293ee
    v_xor_b32 v5, v3, v2
    v_lshlrev_b32 v5, 4, v5
    v_lshl_add_u32 v12, v2, 8, v5
    v_or_b32 v16, s59, v3
    v_and_b32 v17, 12, v2
    v_bfe_u32 v20, v1, 1, 1
    v_or_b32 v17, v17, v20
    v_xor_b32 v17, v17, v16
    v_lshlrev_b32 v17, 4, v17
    v_lshl_or_b32 v17, v21, 3, v17
    v_lshl_add_u32 v10, v16, 8, v17
    s_mov_b32 s62, 0x05040100
    s_mov_b32 s63, 0x07060302
    v_xor_b32 v11, 32, v10
    v_xor_b32 v13, 64, v12
    v_xor_b32 v14, 128, v12
    v_xor_b32 v15, 192, v12
    v_bfe_u32 v16, v1, 1, 1
    v_and_b32 v17, 12, v1
    v_lshlrev_b32 v17, 2, v17
    v_lshl_or_b32 v16, v16, 10, v17
    v_and_b32 v17, 1, v1
    v_lshl_or_b32 v91, v17, 3, v16
    v_lshl_add_u32 v91, v3, 11, v91
    s_lshl2_add_u32 s10, s55, s52
    s_lshl_b32 s10, s10, 6
    s_lshl_b32 s58, s54, 13
    s_add_u32 s10, s10, s58
    s_add_u32 s10, s10, 1048576
    s_lshl_b32 s98, s52, 13
    s_lshl_b32 s57, s53, 8
    s_lshl2_add_u32 s96, s98, 0
    s_add_u32 s96, s96, 2097152
    v_lshrrev_b32 v28, 5, v1
    v_and_b32 v29, 1, v3
    v_lshl_add_u32 v28, v28, 2, v29
    v_lshlrev_b32 v30, 3, v2
    v_lshl_add_u32 v90, v28, 17, v30
    s_and_b32 s58, s52, 1
    s_lshl_b32 s58, s58, 11
    s_xor_b32 s57, s57, s58
    v_lshlrev_b32 v28, 10, v28
    v_xor_b32 v28, s57, v28
    v_add_u32 v90, v90, v28
    s_and_b32 s58, s55, 1
    s_and_b32 s59, s54, 5
    s_lshl1_add_u32 s59, s58, s59
    s_and_b32 s57, s55, 2
    s_lshl_b32 s57, s57, 6
    s_add_u32 s96, s96, s57
    s_lshl_b32 s14, s53, 15
    s_add_u32 s14, s14, s98
    s_add_u32 s14, s14, 2097152
    v_lshlrev_b32 v0, 7, v1
    s_lshl2_add_u32 s13, s53, s52
    s_lshl_b32 s13, s13, 9
    s_add_u32 s13, s13, 6291456
    s_lshl_b32 s57, s55, 5
    s_add_u32 s57, s57, s54
    s_lshl_b32 s57, s57, 4
    s_lshl3_add_u32 s7, s98, s57
    s_add_u32 s7, s7, 6291456
    v_and_b32 v30, 7, v1
    v_xor_b32 v253, s59, v30
    v_lshl_add_u32 v253, v253, 2, v3
    v_lshlrev_b32 v253, 11, v253
    s_mul_i32 s57, s52, 272
    v_and_b32 v252, 8, v1
    v_lshl_add_u32 v252, v252, 2, v30
    v_and_b32 v29, 1, v3
    v_lshl_add_u32 v252, v252, 1, v29
    v_lshl_add_u32 v252, v252, 1, s57
    v_lshrrev_b32 v89, 2, v2
    v_mul_u32_u24 v89, 272, v89
    v_lshl_add_u32 v89, v3, 4, v89
    v_lshl_add_u32 v122, v3, 13, v6
    v_xor_b32 v123, 0x80, v122
    s_lshl2_add_u32 s19, s52, s55
    s_lshl_b32 s19, s19, 10
    s_add_u32 s19, s19, s54
    s_lshl_b32 s19, s19, 8
    s_mov_b64 s[40:41], s[22:23]
    s_mov_b32 s42, 0x400000
    s_mov_b32 s43, 0x20000
    v_xor_b32 v30, v30, v29
    v_and_b32 v29, 1, v30
    v_lshlrev_b32 v29, 4, v29
    v_mov_b32 v28, 0xffff
    v_lshlrev_b32 v29, v29, v28
    v_lshrrev_b32 v30, 1, v30
    v_cmp_eq_u32 vcc, 0, v30
    s_nop 1
    v_cndmask_b32 v248, 0, v29, vcc
    v_cmp_eq_u32 vcc, 1, v30
    s_nop 1
    v_cndmask_b32 v249, 0, v29, vcc
    v_cmp_eq_u32 vcc, 2, v30
    s_nop 1
    v_cndmask_b32 v250, 0, v29, vcc
    v_cmp_eq_u32 vcc, 3, v30
    s_nop 1
    v_cndmask_b32 v251, 0, v29, vcc
    s_and_b32 s4, s54, 28
    s_or_b32 s4, s4, s55
    s_and_b32 s5, s54, 3
    s_xor_b32 s5, s5, 2
    s_lshl2_add_u32 s101, s4, s52
    s_lshl_b32 s101, s101, 7
    s_add_u32 s101, s101, s5
    s_lshl_b32 s101, s101, 8
    s_lshl2_add_u32 s11, s4, s52
    s_lshl_b32 s11, s11, 11
    s_add_u32 s11, s11, 1048576
    v_lshlrev_b32 v88, 3, v2
    v_lshl_add_u32 v88, v3, 14, v88
    s_lshl4_add_u32 s12, s5, s52
    s_lshl_b32 s12, s12, 5
    s_add_u32 s12, s12, s4
    s_lshl_b32 s12, s12, 7
    s_add_u32 s12, s12, 1572864
    s_mov_b32 s28, 0x07060500
    s_mov_b32 s29, 0x07060501
    v_and_b32 v16, 3, v1
    v_bfe_u32 v17, v1, 2, 2
    v_lshl_or_b32 v18, v16, 2, v17
    v_lshrrev_b32 v19, 5, v1
    v_and_or_b32 v21, v1, 16, v18
    v_xor_b32 v18, v18, v19
    v_lshlrev_b32 v18, 4, v18
    v_lshl_add_u32 v21, v21, 8, v18
    v_add_u32 v100, s98, v21
    v_and_b32 v20, 31, v1
    v_lshl_add_u32 v18, v20, 10, v18
    v_add_u32 v108, 0x20000, v18
    v_xor_b32 v101, 32, v100
    v_xor_b32 v109, 32, v108
    v_xor_b32 v102, 64, v100
    v_xor_b32 v110, 64, v108
    v_xor_b32 v103, 96, v100
    v_xor_b32 v111, 96, v108
    v_xor_b32 v104, 128, v100
    v_xor_b32 v112, 128, v108
    v_xor_b32 v105, 160, v100
    v_xor_b32 v113, 160, v108
    v_xor_b32 v106, 192, v100
    v_xor_b32 v114, 192, v108
    v_xor_b32 v107, 224, v100
    v_xor_b32 v115, 224, v108
    v_lshl_or_b32 v17, v17, 2, v19
    v_and_b32 v20, 1, v3
    v_lshrrev_b32 v21, 1, v16
    v_lshl_or_b32 v20, v20, 1, v21
    v_lshl_or_b32 v20, s52, 2, v20
    v_xor_b32 v18, v17, v20
    v_lshlrev_b32 v18, 4, v18
    v_and_b32 v21, 1, v1
    v_lshl_or_b32 v18, v21, 3, v18
    v_lshl_add_u32 v116, v17, 8, v18
    v_xor_b32 v117, 0x220, v116
    v_add_u32 v118, 0x10000, v116
    v_add_u32 v119, 0x10000, v117
    v_lshl_add_u32 v6, v3, 10, v6
    v_xor_b32 v7, 0x80, v6
    s_lshl_b32 s57, s52, 5
    v_add_lshl_u32 v20, v1, s57, 5
    s_and_b32 s57, s53, 0x70
    v_add_u32 v20, 32768, v20
    s_mov_b32 exec_lo, 0
    v_add_lshl_u32 v20, v2, s57, 4
    s_mov_b32 exec_lo, -1
    s_mov_b32 s50, 32768
    s_lshl_b32 s51, s53, 4
    s_lshr_b32 s57, s53, 5
    s_lshl2_add_u32 s57, s57, s52
    s_lshl_b32 s57, s57, 13
    s_add_u32 s57, s57, 131072
    s_add_u32 s58, s57, 4096
    s_and_b32 s59, s52, 1
    s_lshl3_add_u32 s59, s55, s59
    s_lshl_b32 s59, s59, 5
    v_xor_b32 v24, s59, v4
    s_add_u32 s59, s98, 0x20000
    v_add_u32 v24, s59, v24
    s_getreg_b32 s99, hwreg(HW_REG_XCC_ID, 0, 4)
    s_and_b32 s59, s53, 15
    s_lshl_b32 s59, s59, 2
    v_mov_b32 v254, s59
    v_mov_b32 v16, s51
    s_load_dword s56, s[30:31], 0
    v_xor_b32 v25, 64, v24
    v_xor_b32 v26, 128, v24
    v_xor_b32 v27, 192, v24
    v_xor_b32 v28, 16, v24
    v_xor_b32 v29, 80, v24
    v_xor_b32 v30, 144, v24
    v_xor_b32 v31, 208, v24
    s_add_u32 m0, s98, 32768
    s_xor_b32 s60, s49, 256
    buffer_load_dwordx4 v96, s[36:39], s60 offen nt lds
    s_add_u32 m0, s98, 33792
    s_xor_b32 s60, s49, 4352
    buffer_load_dwordx4 v97, s[36:39], s60 offen nt lds
    s_add_u32 m0, s98, 34816
    s_xor_b32 s60, s49, 8448
    buffer_load_dwordx4 v98, s[36:39], s60 offen nt lds
    s_add_u32 m0, s98, 35840
    s_xor_b32 s60, s49, 12544
    buffer_load_dwordx4 v99, s[36:39], s60 offen nt lds
    s_add_u32 m0, s98, 36864
    s_xor_b32 s60, s49, 16640
    buffer_load_dwordx4 v96, s[36:39], s60 offen nt lds
    s_add_u32 m0, s98, 37888
    s_xor_b32 s60, s49, 20736
    buffer_load_dwordx4 v97, s[36:39], s60 offen nt lds
    s_add_u32 m0, s98, 38912
    s_xor_b32 s60, s49, 24832
    buffer_load_dwordx4 v98, s[36:39], s60 offen nt lds
    s_add_u32 m0, s98, 39936
    s_xor_b32 s60, s49, 28928
    buffer_load_dwordx4 v99, s[36:39], s60 offen nt lds
    s_waitcnt lgkmcnt(0)
    s_mov_b32 s61, 0
    s_add_u32 s56, s56, 0x9e3779b1
    s_xor_b32 s99, s99, s56
    v_mov_b32 v93, s56
    v_mov_b32 v92, s99
    s_cmp_lg_u32 s52, 0
    s_cbranch_scc1 L_noidB
    s_mov_b64 exec, 1
    buffer_store_dword v92, v16, s[32:35], s50 offen sc1
    s_mov_b64 exec, -1
L_noidB:
    s_add_u32 m0, s98, 65536
    s_xor_b32 s60, s49, 512
    buffer_load_dwordx4 v96, s[36:39], s60 offen nt lds
    s_add_u32 m0, s98, 66560
    s_xor_b32 s60, s49, 4608
    buffer_load_dwordx4 v97, s[36:39], s60 offen nt lds
    s_add_u32 m0, s98, 67584
    s_xor_b32 s60, s49, 8704
    buffer_load_dwordx4 v98, s[36:39], s60 offen nt lds
    s_add_u32 m0, s98, 68608
    s_xor_b32 s60, s49, 12800
    buffer_load_dwordx4 v99, s[36:39], s60 offen nt lds
    s_add_u32 m0, s98, 69632
    s_xor_b32 s60, s49, 16896
    buffer_load_dwordx4 v96, s[36:39], s60 offen nt lds
    s_add_u32 m0, s98, 70656
    s_xor_b32 s60, s49, 20992
    buffer_load_dwordx4 v97, s[36:39], s60 offen nt lds
    s_add_u32 m0, s98, 71680
    s_xor_b32 s60, s49, 25088
    buffer_load_dwordx4 v98, s[36:39], s60 offen nt lds
    s_add_u32 m0, s98, 72704
    s_xor_b32 s60, s49, 29184
    buffer_load_dwordx4 v99, s[36:39], s60 offen nt lds
    s_waitcnt vmcnt(16)
    s_barrier
    ds_read_b128 a[0:3], v100 offset:0
    ds_read_b128 a[4:7], v101 offset:0
    ds_read_b128 a[8:11], v102 offset:0
    ds_read_b128 a[12:15], v103 offset:0
    ds_read_b128 a[16:19], v104 offset:0
    ds_read_b128 a[20:23], v105 offset:0
    ds_read_b128 a[24:27], v106 offset:0
    ds_read_b128 a[28:31], v107 offset:0
    ds_read_b64_tr_b16 a[128:129], v116 offset:0
    ds_read_b64_tr_b16 a[130:131], v117 offset:0
    ds_read_b64_tr_b16 a[144:145], v116 offset:4096
    ds_read_b64_tr_b16 a[146:147], v117 offset:4096
    ds_read_b64_tr_b16 a[160:161], v116 offset:8192
    ds_read_b64_tr_b16 a[162:163], v117 offset:8192
    ds_read_b64_tr_b16 a[176:177], v116 offset:12288
    ds_read_b64_tr_b16 a[178:179], v117 offset:12288
    ds_read_b64_tr_b16 a[192:193], v116 offset:16384
    ds_read_b64_tr_b16 a[194:195], v117 offset:16384
    ds_read_b64_tr_b16 a[208:209], v116 offset:20480
    ds_read_b64_tr_b16 a[210:211], v117 offset:20480
    ds_read_b64_tr_b16 a[224:225], v116 offset:24576
    ds_read_b64_tr_b16 a[226:227], v117 offset:24576
    ds_read_b64_tr_b16 a[240:241], v116 offset:28672
    ds_read_b64_tr_b16 a[242:243], v117 offset:28672
    s_add_u32 m0, s98, 98304
    s_xor_b32 s60, s49, 768
    buffer_load_dwordx4 v96, s[36:39], s60 offen nt lds
    s_add_u32 m0, s98, 99328
    s_xor_b32 s60, s49, 4864
    buffer_load_dwordx4 v97, s[36:39], s60 offen nt lds
    s_add_u32 m0, s98, 100352
    s_xor_b32 s60, s49, 8960
    buffer_load_dwordx4 v98, s[36:39], s60 offen nt lds
    s_add_u32 m0, s98, 101376
    s_xor_b32 s60, s49, 13056
    buffer_load_dwordx4 v99, s[36:39], s60 offen nt lds
    s_add_u32 m0, s98, 102400
    s_xor_b32 s60, s49, 17152
    buffer_load_dwordx4 v96, s[36:39], s60 offen nt lds
    s_add_u32 m0, s98, 103424
    s_xor_b32 s60, s49, 21248
    buffer_load_dwordx4 v97, s[36:39], s60 offen nt lds
    s_add_u32 m0, s98, 104448
    s_xor_b32 s60, s49, 25344
    buffer_load_dwordx4 v98, s[36:39], s60 offen nt lds
    s_add_u32 m0, s98, 105472
    s_xor_b32 s60, s49, 29440
    buffer_load_dwordx4 v99, s[36:39], s60 offen nt lds
    s_waitcnt vmcnt(16)
    s_barrier
    ds_read_b128 a[32:35], v100 offset:32768
    ds_read_b128 a[36:39], v101 offset:32768
    ds_read_b128 a[40:43], v102 offset:32768
    ds_read_b128 a[44:47], v103 offset:32768
    ds_read_b128 a[48:51], v104 offset:32768
    ds_read_b128 a[52:55], v105 offset:32768
    ds_read_b128 a[56:59], v106 offset:32768
    ds_read_b128 a[60:63], v107 offset:32768
    v_add_u32 v100, 0x10000, v100
    v_add_u32 v101, 0x10000, v101
    v_add_u32 v102, 0x10000, v102
    v_add_u32 v103, 0x10000, v103
    v_add_u32 v104, 0x10000, v104
    v_add_u32 v105, 0x10000, v105
    v_add_u32 v106, 0x10000, v106
    v_add_u32 v107, 0x10000, v107
    ds_read_b64_tr_b16 a[132:133], v116 offset:32768
    ds_read_b64_tr_b16 a[134:135], v117 offset:32768
    ds_read_b64_tr_b16 a[148:149], v116 offset:36864
    ds_read_b64_tr_b16 a[150:151], v117 offset:36864
    ds_read_b64_tr_b16 a[164:165], v116 offset:40960
    ds_read_b64_tr_b16 a[166:167], v117 offset:40960
    ds_read_b64_tr_b16 a[180:181], v116 offset:45056
    ds_read_b64_tr_b16 a[182:183], v117 offset:45056
    ds_read_b64_tr_b16 a[196:197], v116 offset:49152
    ds_read_b64_tr_b16 a[198:199], v117 offset:49152
    ds_read_b64_tr_b16 a[212:213], v116 offset:53248
    ds_read_b64_tr_b16 a[214:215], v117 offset:53248
    ds_read_b64_tr_b16 a[228:229], v116 offset:57344
    ds_read_b64_tr_b16 a[230:231], v117 offset:57344
    ds_read_b64_tr_b16 a[244:245], v116 offset:61440
    ds_read_b64_tr_b16 a[246:247], v117 offset:61440
    buffer_load_dword v124, v20, s[32:35], s50 offen sc1
    s_waitcnt lgkmcnt(0)
    s_barrier
    s_add_u32 m0, s98, 32768
    s_add_u32 s60, s19, 0
    buffer_load_dwordx4 v122, s[40:43], s60 offen nt lds
    s_add_u32 m0, s98, 33792
    s_add_u32 s60, s19, 32768
    buffer_load_dwordx4 v122, s[40:43], s60 offen nt lds
    s_waitcnt vmcnt(2)
    s_branch L_f2
L_f1:
    buffer_load_dword v124, v20, s[32:35], s50 offen sc1
    s_waitcnt vmcnt(0)
L_f2:
    v_xor_b32 v16, s56, v124
    v_cmp_lt_u32 vcc, 15, v16
    s_cbranch_vccz ok_24
    s_add_u32 s61, s61, 1
    s_cmp_lt_u32 s61, 200000
    s_cbranch_scc1 L_f1
ok_24:
    v_cmp_ne_u32 vcc, s99, v124
    s_nop 0
    s_cmp_eq_u32 vcc_hi, 0
    s_cselect_b32 s100, 1, 0
    s_cselect_b32 s97, 0, 0
    s_add_u32 s96, s96, s97
    s_waitcnt vmcnt(11) lgkmcnt(0)
    s_barrier
    ds_read_b128 a[64:67], v100 offset:0
    ds_read_b128 a[68:71], v101 offset:0
    ds_read_b128 a[72:75], v102 offset:0
    ds_read_b128 a[76:79], v103 offset:0
    ds_read_b128 a[80:83], v104 offset:0
    ds_read_b128 a[84:87], v105 offset:0
    ds_read_b128 a[88:91], v106 offset:0
    ds_read_b128 a[92:95], v107 offset:0
    ds_read_b64_tr_b16 a[136:137], v118 offset:0
    ds_read_b64_tr_b16 a[138:139], v119 offset:0
    ds_read_b64_tr_b16 a[152:153], v118 offset:4096
    ds_read_b64_tr_b16 a[154:155], v119 offset:4096
    ds_read_b64_tr_b16 a[168:169], v118 offset:8192
    ds_read_b64_tr_b16 a[170:171], v119 offset:8192
    ds_read_b64_tr_b16 a[184:185], v118 offset:12288
    ds_read_b64_tr_b16 a[186:187], v119 offset:12288
    ds_read_b64_tr_b16 a[200:201], v118 offset:16384
    ds_read_b64_tr_b16 a[202:203], v119 offset:16384
    ds_read_b64_tr_b16 a[216:217], v118 offset:20480
    ds_read_b64_tr_b16 a[218:219], v119 offset:20480
    ds_read_b64_tr_b16 a[232:233], v118 offset:24576
    ds_read_b64_tr_b16 a[234:235], v119 offset:24576
    ds_read_b64_tr_b16 a[248:249], v118 offset:28672
    ds_read_b64_tr_b16 a[250:251], v119 offset:28672
    buffer_load_dwordx4 v[208:211], v4, s[32:35], s57 offen offset:0 sc1
    buffer_load_dwordx4 v[212:215], v4, s[32:35], s57 offen offset:1024 sc1
    buffer_load_dwordx4 v[216:219], v4, s[32:35], s57 offen offset:2048 sc1
    buffer_load_dwordx4 v[220:223], v4, s[32:35], s57 offen offset:3072 sc1
    buffer_load_dwordx4 v[224:227], v4, s[32:35], s58 offen offset:0 sc1
    buffer_load_dwordx4 v[228:231], v4, s[32:35], s58 offen offset:1024 sc1
    buffer_load_dwordx4 v[232:235], v4, s[32:35], s58 offen offset:2048 sc1
    buffer_load_dwordx4 v[236:239], v4, s[32:35], s58 offen offset:3072 sc1
    s_mov_b64 s[36:37], s[24:25]
    s_mov_b32 s38, 0x400000
    s_waitcnt lgkmcnt(0)
    s_barrier
    s_branch L_q2
L_q1:
    s_waitcnt lgkmcnt(0)
    s_mov_b64 exec, vcc
    buffer_load_dwordx4 v[208:211], v4, s[32:35], s57 offen offset:0 sc1
    buffer_load_dwordx4 v[212:215], v4, s[32:35], s57 offen offset:1024 sc1
    buffer_load_dwordx4 v[216:219], v4, s[32:35], s57 offen offset:2048 sc1
    buffer_load_dwordx4 v[220:223], v4, s[32:35], s57 offen offset:3072 sc1
    buffer_load_dwordx4 v[224:227], v4, s[32:35], s58 offen offset:0 sc1
    buffer_load_dwordx4 v[228:231], v4, s[32:35], s58 offen offset:1024 sc1
    buffer_load_dwordx4 v[232:235], v4, s[32:35], s58 offen offset:2048 sc1
    buffer_load_dwordx4 v[236:239], v4, s[32:35], s58 offen offset:3072 sc1
    s_waitcnt vmcnt(0)
L_q2:
    s_waitcnt vmcnt(7)
    ds_write_b128 v24, v[208:211] offset:0
    s_add_u32 m0, s98, 34816
    s_add_u32 s60, s19, 65536
    buffer_load_dwordx4 v123, s[40:43], s60 offen nt lds
    v_max_u32 v16, v208, v209
    v_max3_u32 v16, v16, v210, v211
    s_waitcnt vmcnt(7)
    ds_write_b128 v25, v[212:215] offset:1024
    s_add_u32 m0, s98, 35840
    s_add_u32 s60, s19, 98304
    buffer_load_dwordx4 v123, s[40:43], s60 offen nt lds
    v_max3_u32 v16, v16, v212, v213
    v_max3_u32 v16, v16, v214, v215
    s_waitcnt vmcnt(7)
    ds_write_b128 v26, v[216:219] offset:2048
    s_add_u32 m0, s98, 36864
    s_add_u32 s60, s19, 131072
    buffer_load_dwordx4 v122, s[40:43], s60 offen nt lds
    v_max3_u32 v16, v16, v216, v217
    v_max3_u32 v16, v16, v218, v219
    s_waitcnt vmcnt(7)
    ds_write_b128 v27, v[220:223] offset:3072
    s_add_u32 m0, s98, 37888
    s_add_u32 s60, s19, 163840
    buffer_load_dwordx4 v122, s[40:43], s60 offen nt lds
    v_max3_u32 v16, v16, v220, v221
    v_max3_u32 v16, v16, v222, v223
    s_waitcnt vmcnt(7)
    ds_write_b128 v28, v[224:227] offset:4096
    s_add_u32 m0, s98, 38912
    s_add_u32 s60, s19, 196608
    buffer_load_dwordx4 v123, s[40:43], s60 offen nt lds
    v_max3_u32 v16, v16, v224, v225
    v_max3_u32 v16, v16, v226, v227
    s_waitcnt vmcnt(7)
    ds_write_b128 v29, v[228:231] offset:5120
    s_add_u32 m0, s98, 39936
    s_add_u32 s60, s19, 229376
    buffer_load_dwordx4 v123, s[40:43], s60 offen nt lds
    v_max3_u32 v16, v16, v228, v229
    v_max3_u32 v16, v16, v230, v231
    s_waitcnt vmcnt(7)
    ds_write_b128 v30, v[232:235] offset:6144
    s_add_u32 m0, s98, 65536
    s_add_u32 s60, s101, 0
    buffer_load_dwordx4 v6, s[36:39], s60 offen nt lds
    v_max3_u32 v16, v16, v232, v233
    v_max3_u32 v16, v16, v234, v235
    s_waitcnt vmcnt(7)
    ds_write_b128 v31, v[236:239] offset:7168
    s_add_u32 m0, s98, 66560
    s_add_u32 s60, s101, 4096
    buffer_load_dwordx4 v6, s[36:39], s60 offen nt lds
    v_max3_u32 v16, v16, v236, v237
    v_max3_u32 v16, v16, v238, v239
    v_cmp_eq_u32 vcc, -1, v16
    s_cbranch_vccz ok_25
    s_add_u32 s61, s61, 1
    s_cmp_lt_u32 s61, 200000
    s_cbranch_scc1 L_q1
ok_25:
    s_mov_b64 exec, -1
    s_waitcnt lgkmcnt(0)
    s_barrier
    ds_read_b128 v[208:211], v108 offset:0
    ds_read_b128 v[212:215], v109 offset:0
    ds_read_b128 v[216:219], v110 offset:0
    ds_read_b128 v[220:223], v111 offset:0
    s_waitcnt vmcnt(19)
    ds_read_b128 a[96:99], v100 offset:32768
    ds_read_b128 a[100:103], v101 offset:32768
    ds_read_b128 a[104:107], v102 offset:32768
    ds_read_b128 a[108:111], v103 offset:32768
    ds_read_b128 v[224:227], v112 offset:0
    s_waitcnt lgkmcnt(8)
    v_mfma_f32_32x32x16_bf16 v[192:207], a[0:3], v[208:211], 0
    ds_read_b128 v[228:231], v113 offset:0
    ds_read_b128 a[112:115], v104 offset:32768
    s_waitcnt lgkmcnt(9)
    v_mfma_f32_32x32x16_bf16 v[192:207], a[4:7], v[212:215], v[192:207]
    ds_read_b128 v[232:235], v114 offset:0
    ds_read_b128 a[116:119], v105 offset:32768
    s_waitcnt lgkmcnt(10)
    v_mfma_f32_32x32x16_bf16 v[192:207], a[8:11], v[216:219], v[192:207]
    ds_read_b128 v[236:239], v115 offset:0
    ds_read_b128 a[120:123], v106 offset:32768
    s_waitcnt lgkmcnt(11)
    v_mfma_f32_32x32x16_bf16 v[192:207], a[12:15], v[220:223], v[192:207]
    ds_read_b128 v[208:211], v108 offset:256
    ds_read_b128 a[124:127], v107 offset:32768
    s_waitcnt lgkmcnt(8)
    v_mfma_f32_32x32x16_bf16 v[192:207], a[16:19], v[224:227], v[192:207]
    ds_read_b128 v[212:215], v109 offset:256
    s_waitcnt lgkmcnt(8)
    v_mfma_f32_32x32x16_bf16 v[192:207], a[20:23], v[228:231], v[192:207]
    ds_read_b128 v[216:219], v110 offset:256
    s_waitcnt lgkmcnt(7)
    v_mfma_f32_32x32x16_bf16 v[192:207], a[24:27], v[232:235], v[192:207]
    ds_read_b128 v[220:223], v111 offset:256
    s_waitcnt lgkmcnt(6)
    v_mfma_f32_32x32x16_bf16 v[192:207], a[28:31], v[236:239], v[192:207]
    ds_read_b128 v[224:227], v112 offset:256
    s_waitcnt lgkmcnt(5)
    v_mfma_f32_32x32x16_bf16 v[192:207], a[32:35], v[208:211], v[192:207]
    ds_read_b128 v[228:231], v113 offset:256
    s_waitcnt lgkmcnt(4)
    v_mfma_f32_32x32x16_bf16 v[192:207], a[36:39], v[212:215], v[192:207]
    ds_read_b128 v[232:235], v114 offset:256
    s_waitcnt lgkmcnt(4)
    v_mfma_f32_32x32x16_bf16 v[192:207], a[40:43], v[216:219], v[192:207]
    ds_read_b128 v[236:239], v115 offset:256
    s_waitcnt lgkmcnt(4)
    v_mfma_f32_32x32x16_bf16 v[192:207], a[44:47], v[220:223], v[192:207]
    ds_read_b128 v[208:211], v108 offset:512
    s_waitcnt lgkmcnt(4)
    v_mfma_f32_32x32x16_bf16 v[192:207], a[48:51], v[224:227], v[192:207]
    ds_read_b128 v[212:215], v109 offset:512
    s_waitcnt lgkmcnt(4)
    v_mfma_f32_32x32x16_bf16 v[192:207], a[52:55], v[228:231], v[192:207]
    ds_read_b128 v[216:219], v110 offset:512
    s_waitcnt lgkmcnt(4)
    v_mfma_f32_32x32x16_bf16 v[192:207], a[56:59], v[232:235], v[192:207]
    ds_read_b128 v[220:223], v111 offset:512
    s_waitcnt lgkmcnt(4)
    v_mfma_f32_32x32x16_bf16 v[192:207], a[60:63], v[236:239], v[192:207]
    ds_read_b128 v[224:227], v112 offset:512
    s_waitcnt lgkmcnt(4)
    v_mfma_f32_32x32x16_bf16 v[192:207], a[64:67], v[208:211], v[192:207]
    s_add_u32 m0, s98, 67584
    s_add_u32 s60, s101, 8192
    buffer_load_dwordx4 v7, s[36:39], s60 offen nt lds
    ds_read_b128 v[228:231], v113 offset:512
    s_waitcnt lgkmcnt(4)
    v_mfma_f32_32x32x16_bf16 v[192:207], a[68:71], v[212:215], v[192:207]
    ds_read_b128 v[232:235], v114 offset:512
    s_waitcnt lgkmcnt(4)
    v_mfma_f32_32x32x16_bf16 v[192:207], a[72:75], v[216:219], v[192:207]
    ds_read_b128 v[236:239], v115 offset:512
    s_waitcnt lgkmcnt(4)
    v_mfma_f32_32x32x16_bf16 v[192:207], a[76:79], v[220:223], v[192:207]
    ds_read_b128 v[208:211], v108 offset:768
    s_waitcnt lgkmcnt(4)
    v_mfma_f32_32x32x16_bf16 v[192:207], a[80:83], v[224:227], v[192:207]
    s_add_u32 m0, s98, 68608
    s_add_u32 s60, s101, 12288
    buffer_load_dwordx4 v7, s[36:39], s60 offen nt lds
    ds_read_b128 v[212:215], v109 offset:768
    s_waitcnt lgkmcnt(4)
    v_mfma_f32_32x32x16_bf16 v[192:207], a[84:87], v[228:231], v[192:207]
    ds_read_b128 v[216:219], v110 offset:768
    s_waitcnt lgkmcnt(4)
    v_mfma_f32_32x32x16_bf16 v[192:207], a[88:91], v[232:235], v[192:207]
    ds_read_b128 v[220:223], v111 offset:768
    s_waitcnt lgkmcnt(4)
    v_mfma_f32_32x32x16_bf16 v[192:207], a[92:95], v[236:239], v[192:207]
    ds_read_b128 v[224:227], v112 offset:768
    s_waitcnt lgkmcnt(4)
    v_mfma_f32_32x32x16_bf16 v[192:207], a[96:99], v[208:211], v[192:207]
    s_add_u32 m0, s98, 69632
    s_add_u32 s60, s101, 16384
    buffer_load_dwordx4 v6, s[36:39], s60 offen nt lds
    ds_read_b128 v[228:231], v113 offset:768
    s_waitcnt lgkmcnt(4)
    v_mfma_f32_32x32x16_bf16 v[192:207], a[100:103], v[212:215], v[192:207]
    ds_read_b128 v[232:235], v114 offset:768
    s_waitcnt lgkmcnt(4)
    v_mfma_f32_32x32x16_bf16 v[192:207], a[104:107], v[216:219], v[192:207]
    ds_read_b128 v[236:239], v115 offset:768
    s_waitcnt lgkmcnt(4)
    v_mfma_f32_32x32x16_bf16 v[192:207], a[108:111], v[220:223], v[192:207]
    s_waitcnt lgkmcnt(3)
    v_mfma_f32_32x32x16_bf16 v[192:207], a[112:115], v[224:227], v[192:207]
    s_add_u32 m0, s98, 70656
    s_add_u32 s60, s101, 20480
    buffer_load_dwordx4 v6, s[36:39], s60 offen nt lds
    s_waitcnt lgkmcnt(2)
    v_mfma_f32_32x32x16_bf16 v[192:207], a[116:119], v[228:231], v[192:207]
    s_waitcnt lgkmcnt(1)
    v_mfma_f32_32x32x16_bf16 v[192:207], a[120:123], v[232:235], v[192:207]
    s_waitcnt lgkmcnt(0)
    v_mfma_f32_32x32x16_bf16 v[192:207], a[124:127], v[236:239], v[192:207]
    v_and_b32 v27, 31, v1
    v_lshlrev_b32 v24, 4, v27
    s_lshl_b32 s59, s52, 2
    v_add_u32 v25, s59, v24
    s_lshl_b32 s59, s52, 11
    v_add_u32 v26, s59, v4
    s_nop 5
    v_max3_f32 v16, v192, v193, v194
    v_max3_f32 v17, v195, v196, v197
    v_max3_f32 v16, v16, v198, v199
    v_max3_f32 v17, v17, v200, v201
    v_max3_f32 v16, v16, v202, v203
    v_max3_f32 v17, v17, v204, v205
    v_max3_f32 v16, v16, v206, v207
    v_max_f32 v16, v16, v17
    v_mov_b32 v17, v16
    s_nop 1
    v_permlane32_swap_b32 v16, v17
    v_max_f32 v16, v16, v17
    ds_write_b32 v25, v16 offset:0
    s_waitcnt lgkmcnt(0)
    s_barrier
    ds_read_b128 v[28:31], v24 offset:0
    s_add_u32 m0, s98, 71680
    s_add_u32 s60, s101, 24576
    buffer_load_dwordx4 v7, s[36:39], s60 offen nt lds
    s_add_u32 m0, s98, 72704
    s_add_u32 s60, s101, 28672
    buffer_load_dwordx4 v7, s[36:39], s60 offen nt lds
    s_waitcnt lgkmcnt(0)
    v_max_f32 v18, v28, v29
    v_max3_f32 v18, v18, v30, v31
    v_mul_f32 v18, s3, v18
    v_fma_f32 v192, v192, s3, -v18
    v_fma_f32 v193, v193, s3, -v18
    v_fma_f32 v194, v194, s3, -v18
    v_fma_f32 v195, v195, s3, -v18
    v_fma_f32 v196, v196, s3, -v18
    v_fma_f32 v197, v197, s3, -v18
    v_fma_f32 v198, v198, s3, -v18
    v_fma_f32 v199, v199, s3, -v18
    v_fma_f32 v200, v200, s3, -v18
    v_fma_f32 v201, v201, s3, -v18
    v_fma_f32 v202, v202, s3, -v18
    v_fma_f32 v203, v203, s3, -v18
    v_fma_f32 v204, v204, s3, -v18
    v_fma_f32 v205, v205, s3, -v18
    v_fma_f32 v206, v206, s3, -v18
    v_fma_f32 v207, v207, s3, -v18
    v_exp_f32 v192, v192
    v_exp_f32 v193, v193
    v_exp_f32 v194, v194
    v_exp_f32 v195, v195
    v_exp_f32 v196, v196
    v_exp_f32 v197, v197
    v_exp_f32 v198, v198
    v_exp_f32 v199, v199
    v_exp_f32 v200, v200
    v_exp_f32 v201, v201
    v_exp_f32 v202, v202
    v_exp_f32 v203, v203
    v_exp_f32 v204, v204
    v_exp_f32 v205, v205
    v_exp_f32 v206, v206
    v_exp_f32 v207, v207
    v_cvt_pk_bf16_f32 v208, v192, v193
    v_cvt_pk_bf16_f32 v209, v194, v195
    v_cvt_pk_bf16_f32 v210, v196, v197
    v_cvt_pk_bf16_f32 v211, v198, v199
    v_cvt_pk_bf16_f32 v212, v200, v201
    v_cvt_pk_bf16_f32 v213, v202, v203
    v_cvt_pk_bf16_f32 v214, v204, v205
    v_cvt_pk_bf16_f32 v215, v206, v207
    ds_write_b128 v26, v[208:211] offset:4096
    ds_write_b128 v26, v[212:215] offset:5120
    v_add_f32 v192, v192, v200
    v_add_f32 v193, v193, v201
    v_add_f32 v194, v194, v202
    v_add_f32 v195, v195, v203
    v_add_f32 v196, v196, v204
    v_add_f32 v197, v197, v205
    v_add_f32 v198, v198, v206
    v_add_f32 v199, v199, v207
    v_add_f32 v192, v192, v196
    v_add_f32 v193, v193, v197
    v_add_f32 v194, v194, v198
    v_add_f32 v195, v195, v199
    v_add_f32 v192, v192, v194
    v_add_f32 v193, v193, v195
    v_add_f32 v192, v192, v193
    v_mov_b32 v17, v192
    s_nop 1
    v_permlane32_swap_b32 v192, v17
    v_add_f32 v16, v192, v17
    ds_write_b32 v25, v16 offset:512
    s_waitcnt lgkmcnt(0)
    s_barrier
    s_add_u32 s14, s14, s97
    s_add_u32 s15, s14, 4096
    ds_read_b128 v[208:211], v4 offset:4096
    ds_read_b128 v[212:215], v4 offset:5120
    ds_read_b128 v[216:219], v4 offset:6144
    ds_read_b128 v[220:223], v4 offset:7168
    ds_read_b128 v[224:227], v4 offset:8192
    ds_read_b128 v[228:231], v4 offset:9216
    ds_read_b128 v[232:235], v4 offset:10240
    ds_read_b128 v[236:239], v4 offset:11264
    ds_read_b128 v[28:31], v24 offset:512
    s_waitcnt lgkmcnt(8)
    v_mfma_f32_32x32x16_bf16 v[128:143], v[208:211], a[128:131], 0
    v_mfma_f32_32x32x16_bf16 v[144:159], v[208:211], a[132:135], 0
    s_waitcnt lgkmcnt(7)
    v_mfma_f32_32x32x16_bf16 v[128:143], v[212:215], a[144:147], v[128:143]
    v_mfma_f32_32x32x16_bf16 v[144:159], v[212:215], a[148:151], v[144:159]
    s_waitcnt lgkmcnt(6)
    v_mfma_f32_32x32x16_bf16 v[128:143], v[216:219], a[160:163], v[128:143]
    v_mfma_f32_32x32x16_bf16 v[144:159], v[216:219], a[164:167], v[144:159]
    s_waitcnt lgkmcnt(0)
    v_mfma_f32_32x32x16_bf16 v[128:143], v[220:223], a[176:179], v[128:143]
    ds_read_b64_tr_b16 a[140:141], v118 offset:32768
    ds_read_b64_tr_b16 a[142:143], v119 offset:32768
    v_mfma_f32_32x32x16_bf16 v[144:159], v[220:223], a[180:183], v[144:159]
    ds_read_b64_tr_b16 a[156:157], v118 offset:36864
    ds_read_b64_tr_b16 a[158:159], v119 offset:36864
    v_mfma_f32_32x32x16_bf16 v[128:143], v[224:227], a[192:195], v[128:143]
    ds_read_b64_tr_b16 a[172:173], v118 offset:40960
    ds_read_b64_tr_b16 a[174:175], v119 offset:40960
    v_mfma_f32_32x32x16_bf16 v[144:159], v[224:227], a[196:199], v[144:159]
    ds_read_b64_tr_b16 a[188:189], v118 offset:45056
    ds_read_b64_tr_b16 a[190:191], v119 offset:45056
    v_add_f32 v28, v28, v29
    v_add_f32 v30, v30, v31
    v_add_f32 v19, v28, v30
    v_mov_b32 v21, s56
    v_mfma_f32_32x32x16_bf16 v[128:143], v[228:231], a[208:211], v[128:143]
    ds_read_b64_tr_b16 a[204:205], v118 offset:49152
    ds_read_b64_tr_b16 a[206:207], v119 offset:49152
    v_mfma_f32_32x32x16_bf16 v[144:159], v[228:231], a[212:215], v[144:159]
    ds_read_b64_tr_b16 a[220:221], v118 offset:53248
    ds_read_b64_tr_b16 a[222:223], v119 offset:53248
    v_mfma_f32_32x32x16_bf16 v[128:143], v[232:235], a[224:227], v[128:143]
    ds_read_b64_tr_b16 a[236:237], v118 offset:57344
    ds_read_b64_tr_b16 a[238:239], v119 offset:57344
    v_mfma_f32_32x32x16_bf16 v[144:159], v[232:235], a[228:231], v[144:159]
    ds_read_b64_tr_b16 a[252:253], v118 offset:61440
    ds_read_b64_tr_b16 a[254:255], v119 offset:61440
    v_mfma_f32_32x32x16_bf16 v[128:143], v[236:239], a[240:243], v[128:143]
    v_mfma_f32_32x32x16_bf16 v[144:159], v[236:239], a[244:247], v[144:159]
    v_mfma_f32_32x32x16_bf16 v[160:175], v[208:211], a[136:139], 0
    s_waitcnt lgkmcnt(0)
    v_mfma_f32_32x32x16_bf16 v[176:191], v[208:211], a[140:143], 0
    s_nop 8
    v_cvt_pk_bf16_f32 v192, v128, v144
    v_cvt_pk_bf16_f32 v193, v129, v145
    v_mfma_f32_32x32x16_bf16 v[160:175], v[212:215], a[152:155], v[160:175]
    s_add_u32 s60, s96, 0
    v_permlane16_swap_b32 v192, v193
    buffer_store_dwordx2 v[192:193], v90, s[32:35], s60 offen sc1
    v_mfma_f32_32x32x16_bf16 v[176:191], v[212:215], a[156:159], v[176:191]
    v_cvt_pk_bf16_f32 v194, v130, v146
    v_cvt_pk_bf16_f32 v195, v131, v147
    v_mfma_f32_32x32x16_bf16 v[160:175], v[216:219], a[168:171], v[160:175]
    s_add_u32 s60, s96, 262144
    v_permlane16_swap_b32 v194, v195
    buffer_store_dwordx2 v[194:195], v90, s[32:35], s60 offen sc1
    v_mfma_f32_32x32x16_bf16 v[176:191], v[216:219], a[172:175], v[176:191]
    v_cvt_pk_bf16_f32 v196, v132, v148
    v_cvt_pk_bf16_f32 v197, v133, v149
    v_mfma_f32_32x32x16_bf16 v[160:175], v[220:223], a[184:187], v[160:175]
    s_add_u32 s60, s96, 1048576
    v_permlane16_swap_b32 v196, v197
    buffer_store_dwordx2 v[196:197], v90, s[32:35], s60 offen sc1
    v_mfma_f32_32x32x16_bf16 v[176:191], v[220:223], a[188:191], v[176:191]
    v_cvt_pk_bf16_f32 v198, v134, v150
    v_cvt_pk_bf16_f32 v199, v135, v151
    v_mfma_f32_32x32x16_bf16 v[160:175], v[224:227], a[200:203], v[160:175]
    s_add_u32 s60, s96, 1310720
    v_permlane16_swap_b32 v198, v199
    buffer_store_dwordx2 v[198:199], v90, s[32:35], s60 offen sc1
    v_mfma_f32_32x32x16_bf16 v[176:191], v[224:227], a[204:207], v[176:191]
    v_cvt_pk_bf16_f32 v200, v136, v152
    v_cvt_pk_bf16_f32 v201, v137, v153
    v_mfma_f32_32x32x16_bf16 v[160:175], v[228:231], a[216:219], v[160:175]
    s_add_u32 s60, s96, 2097152
    v_permlane16_swap_b32 v200, v201
    buffer_store_dwordx2 v[200:201], v90, s[32:35], s60 offen sc1
    v_mfma_f32_32x32x16_bf16 v[176:191], v[228:231], a[220:223], v[176:191]
    v_cvt_pk_bf16_f32 v202, v138, v154
    v_cvt_pk_bf16_f32 v203, v139, v155
    v_mfma_f32_32x32x16_bf16 v[160:175], v[232:235], a[232:235], v[160:175]
    s_add_u32 s60, s96, 2359296
    v_permlane16_swap_b32 v202, v203
    buffer_store_dwordx2 v[202:203], v90, s[32:35], s60 offen sc1
    v_mfma_f32_32x32x16_bf16 v[176:191], v[232:235], a[236:239], v[176:191]
    v_cvt_pk_bf16_f32 v204, v140, v156
    v_cvt_pk_bf16_f32 v205, v141, v157
    v_mfma_f32_32x32x16_bf16 v[160:175], v[236:239], a[248:251], v[160:175]
    s_add_u32 s60, s96, 3145728
    v_permlane16_swap_b32 v204, v205
    buffer_store_dwordx2 v[204:205], v90, s[32:35], s60 offen sc1
    v_mfma_f32_32x32x16_bf16 v[176:191], v[236:239], a[252:255], v[176:191]
    v_cvt_pk_bf16_f32 v206, v142, v158
    v_cvt_pk_bf16_f32 v207, v143, v159
    s_add_u32 s60, s96, 3407872
    s_nop 0
    v_permlane16_swap_b32 v206, v207
    buffer_store_dwordx2 v[206:207], v90, s[32:35], s60 offen sc1
    s_nop 5
    v_cvt_pk_bf16_f32 v32, v160, v176
    v_cvt_pk_bf16_f32 v33, v161, v177
    s_xor_b32 s96, s96, 128
    v_cvt_pk_bf16_f32 v34, v162, v178
    v_cvt_pk_bf16_f32 v35, v163, v179
    s_add_u32 s60, s96, 0
    v_permlane16_swap_b32 v32, v33
    buffer_store_dwordx2 v[32:33], v90, s[32:35], s60 offen sc1
    v_cvt_pk_bf16_f32 v36, v164, v180
    v_cvt_pk_bf16_f32 v37, v165, v181
    s_add_u32 s60, s96, 262144
    v_permlane16_swap_b32 v34, v35
    buffer_store_dwordx2 v[34:35], v90, s[32:35], s60 offen sc1
    v_cvt_pk_bf16_f32 v38, v166, v182
    v_cvt_pk_bf16_f32 v39, v167, v183
    s_add_u32 s60, s96, 1048576
    v_permlane16_swap_b32 v36, v37
    buffer_store_dwordx2 v[36:37], v90, s[32:35], s60 offen sc1
    v_cvt_pk_bf16_f32 v40, v168, v184
    v_cvt_pk_bf16_f32 v41, v169, v185
    s_add_u32 s60, s96, 1310720
    v_permlane16_swap_b32 v38, v39
    buffer_store_dwordx2 v[38:39], v90, s[32:35], s60 offen sc1
    v_cvt_pk_bf16_f32 v42, v170, v186
    v_cvt_pk_bf16_f32 v43, v171, v187
    s_add_u32 s60, s96, 2097152
    v_permlane16_swap_b32 v40, v41
    buffer_store_dwordx2 v[40:41], v90, s[32:35], s60 offen sc1
    v_cvt_pk_bf16_f32 v44, v172, v188
    v_cvt_pk_bf16_f32 v45, v173, v189
    s_add_u32 s60, s96, 2359296
    v_permlane16_swap_b32 v42, v43
    buffer_store_dwordx2 v[42:43], v90, s[32:35], s60 offen sc1
    v_cvt_pk_bf16_f32 v46, v174, v190
    v_cvt_pk_bf16_f32 v47, v175, v191
    s_add_u32 s60, s96, 3145728
    v_permlane16_swap_b32 v44, v45
    buffer_store_dwordx2 v[44:45], v90, s[32:35], s60 offen sc1
    s_add_u32 s60, s96, 3407872
    v_permlane16_swap_b32 v46, v47
    buffer_store_dwordx2 v[46:47], v90, s[32:35], s60 offen sc1
    s_waitcnt vmcnt(0)
    s_mov_b32 exec_hi, 0
    buffer_store_dwordx4 v[18:21], v4, s[32:35], s13 offen sc1
    s_mov_b64 exec, 0xffff
    buffer_load_dword v255, v0, s[32:35], s11 offen nt
    buffer_load_dword v255, v0, s[32:35], s11 offen sc1
    s_mov_b64 exec, -1
    s_nop 3
    s_barrier
    ds_read_b64_tr_b16 v[160:161], v8 offset:0
    ds_read_b64_tr_b16 v[162:163], v8 offset:1024
    ds_read_b64_tr_b16 v[164:165], v9 offset:0
    ds_read_b64_tr_b16 v[166:167], v9 offset:1024
    ds_read_b64_tr_b16 v[168:169], v8 offset:8192
    ds_read_b64_tr_b16 v[170:171], v8 offset:9216
    ds_read_b64_tr_b16 v[172:173], v9 offset:8192
    ds_read_b64_tr_b16 v[174:175], v9 offset:9216
    ds_read_b64_tr_b16 v[176:177], v8 offset:16384
    ds_read_b64_tr_b16 v[178:179], v8 offset:17408
    ds_read_b64_tr_b16 v[180:181], v9 offset:16384
    ds_read_b64_tr_b16 v[182:183], v9 offset:17408
    ds_read_b64_tr_b16 v[184:185], v8 offset:24576
    ds_read_b64_tr_b16 v[186:187], v8 offset:25600
    ds_read_b64_tr_b16 v[188:189], v9 offset:24576
    ds_read_b64_tr_b16 v[190:191], v9 offset:25600
    s_waitcnt vmcnt(0)
L_fp:
    buffer_load_dwordx4 v[124:127], v253, s[32:35], s7 offen sc1
    s_waitcnt vmcnt(0)
    v_cmp_ne_u32 vcc, s56, v127
    s_nop 0
    s_mov_b64 exec, vcc
    s_cbranch_vccz ok_26
    s_add_u32 s61, s61, 1
    s_cmp_lt_u32 s61, 200000
    s_cbranch_scc1 L_fp
ok_26:
    s_mov_b64 exec, -1
    s_nop 3
    buffer_load_dwordx4 v[208:211], v4, s[32:35], s14 offen offset:0 sc1
    buffer_load_dwordx4 v[212:215], v4, s[32:35], s14 offen offset:1024 sc1
    buffer_load_dwordx4 v[216:219], v4, s[32:35], s14 offen offset:2048 sc1
    buffer_load_dwordx4 v[220:223], v4, s[32:35], s14 offen offset:3072 sc1
    buffer_load_dwordx4 v[224:227], v4, s[32:35], s15 offen offset:0 sc1
    buffer_load_dwordx4 v[228:231], v4, s[32:35], s15 offen offset:1024 sc1
    buffer_load_dwordx4 v[232:235], v4, s[32:35], s15 offen offset:2048 sc1
    buffer_load_dwordx4 v[236:239], v4, s[32:35], s15 offen offset:3072 sc1
    v_max_f32_dpp v16, v124, v124 row_ror:4 row_mask:0xf bank_mask:0xf
    s_nop 1
    v_max_f32_dpp v16, v16, v16 row_ror:2 row_mask:0xf bank_mask:0xf
    s_nop 1
    v_max_f32_dpp v16, v16, v16 row_ror:1 row_mask:0xf bank_mask:0xf
    v_mov_b32 v20, v16
    s_nop 1
    v_permlane16_swap_b32 v16, v20
    v_max_f32 v16, v16, v20
    v_mov_b32 v20, v16
    s_nop 1
    v_permlane32_swap_b32 v16, v20
    v_max_f32 v16, v16, v20
    v_sub_f32 v18, v124, v16
    v_exp_f32 v18, v18
    s_nop 0
    v_mul_f32 v17, v18, v125
    s_nop 1
    v_add_f32_dpp v17, v17, v17 row_ror:4 row_mask:0xf bank_mask:0xf
    s_nop 1
    v_add_f32_dpp v17, v17, v17 row_ror:2 row_mask:0xf bank_mask:0xf
    s_nop 1
    v_add_f32_dpp v17, v17, v17 row_ror:1 row_mask:0xf bank_mask:0xf
    v_mov_b32 v20, v17
    s_nop 1
    v_permlane16_swap_b32 v17, v20
    v_add_f32 v17, v17, v20
    v_mov_b32 v20, v17
    s_nop 1
    v_permlane32_swap_b32 v17, v20
    v_add_f32 v17, v17, v20
    v_rcp_f32 v19, v17
    s_nop 0
    v_mul_f32 v18, v19, v18
    v_cvt_pk_bf16_f32 v18, v18, v18
    s_nop 1
    v_and_b32_dpp v48, v18, v248 row_newbcast:0 row_mask:0xf bank_mask:0xf
    v_and_b32_dpp v49, v18, v249 row_newbcast:0 row_mask:0xf bank_mask:0xf
    v_and_b32_dpp v50, v18, v250 row_newbcast:0 row_mask:0xf bank_mask:0xf
    v_and_b32_dpp v51, v18, v251 row_newbcast:0 row_mask:0xf bank_mask:0xf
    v_and_b32_dpp v52, v18, v248 row_newbcast:1 row_mask:0xf bank_mask:0xf
    v_and_b32_dpp v53, v18, v249 row_newbcast:1 row_mask:0xf bank_mask:0xf
    v_and_b32_dpp v54, v18, v250 row_newbcast:1 row_mask:0xf bank_mask:0xf
    v_and_b32_dpp v55, v18, v251 row_newbcast:1 row_mask:0xf bank_mask:0xf
    v_and_b32_dpp v56, v18, v248 row_newbcast:2 row_mask:0xf bank_mask:0xf
    v_and_b32_dpp v57, v18, v249 row_newbcast:2 row_mask:0xf bank_mask:0xf
    v_and_b32_dpp v58, v18, v250 row_newbcast:2 row_mask:0xf bank_mask:0xf
    v_and_b32_dpp v59, v18, v251 row_newbcast:2 row_mask:0xf bank_mask:0xf
    v_and_b32_dpp v60, v18, v248 row_newbcast:3 row_mask:0xf bank_mask:0xf
    v_and_b32_dpp v61, v18, v249 row_newbcast:3 row_mask:0xf bank_mask:0xf
    v_and_b32_dpp v62, v18, v250 row_newbcast:3 row_mask:0xf bank_mask:0xf
    v_and_b32_dpp v63, v18, v251 row_newbcast:3 row_mask:0xf bank_mask:0xf
    v_and_b32_dpp v64, v18, v248 row_newbcast:4 row_mask:0xf bank_mask:0xf
    v_and_b32_dpp v65, v18, v249 row_newbcast:4 row_mask:0xf bank_mask:0xf
    v_and_b32_dpp v66, v18, v250 row_newbcast:4 row_mask:0xf bank_mask:0xf
    v_and_b32_dpp v67, v18, v251 row_newbcast:4 row_mask:0xf bank_mask:0xf
    v_and_b32_dpp v68, v18, v248 row_newbcast:5 row_mask:0xf bank_mask:0xf
    v_and_b32_dpp v69, v18, v249 row_newbcast:5 row_mask:0xf bank_mask:0xf
    v_and_b32_dpp v70, v18, v250 row_newbcast:5 row_mask:0xf bank_mask:0xf
    v_and_b32_dpp v71, v18, v251 row_newbcast:5 row_mask:0xf bank_mask:0xf
    v_and_b32_dpp v72, v18, v248 row_newbcast:6 row_mask:0xf bank_mask:0xf
    v_and_b32_dpp v73, v18, v249 row_newbcast:6 row_mask:0xf bank_mask:0xf
    v_and_b32_dpp v74, v18, v250 row_newbcast:6 row_mask:0xf bank_mask:0xf
    v_and_b32_dpp v75, v18, v251 row_newbcast:6 row_mask:0xf bank_mask:0xf
    v_and_b32_dpp v76, v18, v248 row_newbcast:7 row_mask:0xf bank_mask:0xf
    v_and_b32_dpp v77, v18, v249 row_newbcast:7 row_mask:0xf bank_mask:0xf
    v_and_b32_dpp v78, v18, v250 row_newbcast:7 row_mask:0xf bank_mask:0xf
    v_and_b32_dpp v79, v18, v251 row_newbcast:7 row_mask:0xf bank_mask:0xf
    s_waitcnt vmcnt(7)
    v_mfma_f32_16x16x32_bf16 v[80:83], v[48:51], v[208:211], 0
    s_waitcnt vmcnt(6)
    v_mfma_f32_16x16x32_bf16 v[80:83], v[52:55], v[212:215], v[80:83]
    s_waitcnt vmcnt(5)
    v_mfma_f32_16x16x32_bf16 v[80:83], v[56:59], v[216:219], v[80:83]
    s_waitcnt vmcnt(4)
    v_mfma_f32_16x16x32_bf16 v[80:83], v[60:63], v[220:223], v[80:83]
    s_waitcnt vmcnt(3)
    v_mfma_f32_16x16x32_bf16 v[80:83], v[64:67], v[224:227], v[80:83]
    s_waitcnt vmcnt(2)
    v_mfma_f32_16x16x32_bf16 v[80:83], v[68:71], v[228:231], v[80:83]
    s_waitcnt vmcnt(1)
    v_mfma_f32_16x16x32_bf16 v[80:83], v[72:75], v[232:235], v[80:83]
    s_waitcnt vmcnt(0)
    v_mfma_f32_16x16x32_bf16 v[80:83], v[76:79], v[236:239], v[80:83]
    s_nop 7
    v_cvt_pk_bf16_f32 v124, v80, v81
    v_cvt_pk_bf16_f32 v125, v82, v83
    ds_write_b16 v252, v124 offset:16384
    ds_write_b16_d16_hi v252, v124 offset:16448
    ds_write_b16 v252, v125 offset:16416
    ds_write_b16_d16_hi v252, v125 offset:16480
    s_waitcnt lgkmcnt(0)
    s_barrier
    ds_read_b128 v[32:35], v89 offset:16384
    ds_read_b128 v[36:39], v89 offset:16448
    ds_read_b128 v[40:43], v89 offset:16512
    ds_read_b128 v[44:47], v89 offset:16576
    s_waitcnt lgkmcnt(3)
    v_mfma_f32_16x16x32_bf16 v[80:83], v[32:35], v[160:163], 0
    v_mfma_f32_16x16x32_bf16 v[84:87], v[32:35], v[164:167], 0
    s_waitcnt lgkmcnt(2)
    v_mfma_f32_16x16x32_bf16 v[80:83], v[36:39], v[168:171], v[80:83]
    v_mfma_f32_16x16x32_bf16 v[84:87], v[36:39], v[172:175], v[84:87]
    s_waitcnt lgkmcnt(1)
    v_mfma_f32_16x16x32_bf16 v[80:83], v[40:43], v[176:179], v[80:83]
    v_mfma_f32_16x16x32_bf16 v[84:87], v[40:43], v[180:183], v[84:87]
    s_waitcnt lgkmcnt(0)
    v_mfma_f32_16x16x32_bf16 v[80:83], v[44:47], v[184:187], v[80:83]
    v_mfma_f32_16x16x32_bf16 v[84:87], v[44:47], v[188:191], v[84:87]
    s_nop 7
    v_cvt_pk_bf16_f32 v92, v80, v84
    s_cmp_eq_u32 s100, 0
    s_cbranch_scc1 slow_27
    buffer_store_dwordx2 v[92:93], v91, s[32:35], s10 offen
back_28:
    ds_read_b64_tr_b16 v[128:129], v8 offset:32768
    ds_read_b64_tr_b16 v[130:131], v8 offset:33792
    ds_read_b64_tr_b16 v[132:133], v9 offset:32768
    ds_read_b64_tr_b16 v[134:135], v9 offset:33792
    ds_read_b64_tr_b16 v[136:137], v8 offset:40960
    ds_read_b64_tr_b16 v[138:139], v8 offset:41984
    ds_read_b64_tr_b16 v[140:141], v9 offset:40960
    ds_read_b64_tr_b16 v[142:143], v9 offset:41984
    ds_read_b64_tr_b16 v[144:145], v8 offset:49152
    ds_read_b64_tr_b16 v[146:147], v8 offset:50176
    ds_read_b64_tr_b16 v[148:149], v9 offset:49152
    ds_read_b64_tr_b16 v[150:151], v9 offset:50176
    ds_read_b64_tr_b16 v[152:153], v8 offset:57344
    ds_read_b64_tr_b16 v[154:155], v8 offset:58368
    ds_read_b64_tr_b16 v[156:157], v9 offset:57344
    ds_read_b64_tr_b16 v[158:159], v9 offset:58368
    buffer_load_dwordx4 v[240:243], v4, s[32:35], s11 offen offset:0 sc1
    buffer_load_dwordx4 v[244:247], v4, s[32:35], s11 offen offset:1024 sc1
    s_waitcnt vmcnt(0)
    s_branch rcv_30
rcv_29:
    buffer_load_dwordx4 v[240:243], v4, s[32:35], s11 offen offset:0 sc1
    buffer_load_dwordx4 v[244:247], v4, s[32:35], s11 offen offset:1024 sc1
    s_waitcnt vmcnt(0)
rcv_30:
    v_bitop3_b32 v16, v241, v243, s56 bitop3:0x7e
    v_bitop3_b32 v16, v16, v245, s56 bitop3:0xf6
    v_bitop3_b32 v16, v16, v247, s56 bitop3:0xf6
    v_cmp_ne_u32 vcc, 0, v16
    s_cbranch_vccz ok_31
    s_add_u32 s61, s61, 1
    s_cmp_lt_u32 s61, 200000
    s_cbranch_scc1 rcv_29
ok_31:
    v_perm_b32 v16, v242, v240, s62
    v_perm_b32 v17, v246, v244, s62
    v_perm_b32 v18, v242, v240, s63
    v_perm_b32 v19, v246, v244, s63
    ds_write_b64 v10, v[16:17] offset:12288
    ds_write_b64 v11, v[18:19] offset:12288
    s_waitcnt lgkmcnt(0)
    s_barrier
    ds_read_b128 v[32:35], v12 offset:12288
    ds_read_b128 v[36:39], v13 offset:12288
    ds_read_b128 v[40:43], v14 offset:12288
    ds_read_b128 v[44:47], v15 offset:12288
    s_waitcnt lgkmcnt(3)
    v_mfma_f32_16x16x32_bf16 v[80:83], v[32:35], v[128:131], 0
    v_mfma_f32_16x16x32_bf16 v[84:87], v[32:35], v[132:135], 0
    s_waitcnt lgkmcnt(2)
    v_mfma_f32_16x16x32_bf16 v[80:83], v[36:39], v[136:139], v[80:83]
    v_mfma_f32_16x16x32_bf16 v[84:87], v[36:39], v[140:143], v[84:87]
    s_waitcnt lgkmcnt(1)
    v_mfma_f32_16x16x32_bf16 v[80:83], v[40:43], v[144:147], v[80:83]
    v_mfma_f32_16x16x32_bf16 v[84:87], v[40:43], v[148:151], v[84:87]
    s_waitcnt lgkmcnt(0)
    v_mfma_f32_16x16x32_bf16 v[80:83], v[44:47], v[152:155], v[80:83]
    v_mfma_f32_16x16x32_bf16 v[84:87], v[44:47], v[156:159], v[84:87]
    s_nop 6
    v_add_f32 v80, v80, v81
    v_add_f32 v82, v82, v83
    v_add_f32 v84, v84, v85
    v_add_f32 v86, v86, v87
    v_add_f32 v16, v80, v82
    v_add_f32 v17, v84, v86
    v_perm_b32 v16, v16, v93, s28
    v_perm_b32 v17, v17, v93, s29
    buffer_store_dwordx2 v[16:17], v88, s[32:35], s12 offen sc1
    s_waitcnt vmcnt(0)
    s_barrier
    s_and_b32 s57, s53, 1
    s_or_b32 s57, s57, s52
    s_cmp_lg_u32 s57, 0
    s_cbranch_scc1 fin_32
    s_lshl_b32 s57, s53, 11
    s_add_u32 s57, s57, 1572864
    s_bfe_u32 s58, s53, 0x20003
    s_lshl1_add_u32 s58, s58, 1
    s_lshr_b32 s59, s53, 5
    s_lshl2_add_u32 s58, s58, s59
    s_bfe_u32 s59, s53, 0x20001
    s_lshl2_add_u32 s58, s58, s59
    s_lshl_b32 s58, s58, 6
    s_lshr_b32 s59, s56, 8
    v_and_b32 v89, 7, v1
    v_lshlrev_b32 v89, 2, v89
    v_and_or_b32 v89, v1, 32, v89
    s_mov_b64 s[48:49], s[26:27]
    s_mov_b32 s50, 0x2000
    s_mov_b32 s51, 0x20000
    s_waitcnt vmcnt(0)
    s_mov_b64 vcc, -1
red_33:
    s_mov_b64 exec, vcc
    buffer_load_dwordx4 v[32:35], v4, s[32:35], s57 offen offset:0 sc1
    buffer_load_dwordx4 v[36:39], v4, s[32:35], s57 offen offset:1024 sc1
    buffer_load_dwordx4 v[40:43], v4, s[32:35], s57 offen offset:2048 sc1
    buffer_load_dwordx4 v[44:47], v4, s[32:35], s57 offen offset:3072 sc1
    s_waitcnt vmcnt(2)
    v_bitop3_b32 v24, v32, v34, s56 bitop3:0x7e
    v_bitop3_b32 v25, v33, v35, s59 bitop3:0x7e
    v_bitop3_b32 v26, v36, v38, s56 bitop3:0x7e
    v_bitop3_b32 v27, v37, v39, s59 bitop3:0x7e
    v_or3_b32 v24, v24, v25, v26
    v_add_f32 v20, v32, v36
    v_add_f32 v21, v33, v37
    v_add_f32 v22, v34, v38
    v_add_f32 v23, v35, v39
    s_waitcnt vmcnt(0)
    v_bitop3_b32 v28, v40, v42, s56 bitop3:0x7e
    v_bitop3_b32 v29, v41, v43, s59 bitop3:0x7e
    v_bitop3_b32 v30, v44, v46, s56 bitop3:0x7e
    v_bitop3_b32 v31, v45, v47, s59 bitop3:0x7e
    v_or3_b32 v24, v24, v27, v28
    v_or3_b32 v29, v29, v30, v31
    v_or_b32 v24, v24, v29
    v_and_b32 v24, 0xff, v24
    v_cmp_ne_u32 vcc, 0, v24
    s_cbranch_vccz ok_34
    s_add_u32 s61, s61, 1
    s_cmp_lt_u32 s61, 200000
    s_cbranch_scc1 red_33
ok_34:
    s_mov_b64 exec, -1
    v_add_f32 v32, v40, v44
    v_add_f32 v33, v41, v45
    v_add_f32 v34, v42, v46
    v_add_f32 v35, v43, v47
    v_add_f32 v20, v20, v32
    v_add_f32 v21, v21, v33
    v_add_f32 v22, v22, v34
    v_add_f32 v23, v23, v35
    v_permlane32_swap_b32 v20, v21
    s_nop 0
    v_permlane32_swap_b32 v22, v23
    v_add_f32 v20, v20, v21
    v_add_f32 v22, v22, v23
    v_mov_b32 v21, v20
    v_mov_b32 v23, v22
    s_nop 0
    v_permlane16_swap_b32 v20, v21
    v_permlane16_swap_b32 v22, v23
    v_add_f32 v20, v20, v21
    v_add_f32 v22, v22, v23
    s_nop 0
    v_add_f32_dpp v20, v20, v20 row_ror:8 row_mask:0xf bank_mask:0xf
    v_add_f32_dpp v22, v22, v22 row_ror:8 row_mask:0xf bank_mask:0xf
    v_cvt_pk_bf16_f32 v20, v20, v22
    s_mov_b32 exec_lo, 0xff
    s_mov_b32 exec_hi, 0xff
    buffer_store_dword v20, v89, s[48:51], s58 offen
    s_cmp_lg_u32 s53, 0
    s_cbranch_scc1 fin_32
    s_mov_b64 exec, 1
    v_mov_b32 v17, 0
    buffer_store_dword v93, v17, s[32:35], 0 offen sc1
fin_32:
    s_endpgm
L_end:
    s_endpgm
slow_12:
    s_nop 15
    buffer_store_dwordx2 v[92:93], v89, s[32:35], s98 offen sc1
    s_waitcnt vmcnt(0)
    s_branch back_13
slow_14:
    s_nop 15
    buffer_store_dwordx4 v[20:23], v28, s[32:35], s57 offen sc1
    s_branch back_15
slow_16:
    s_nop 15
    buffer_store_dwordx2 v[92:93], v89, s[32:35], s98 offen sc1
    s_branch back_17
slow_27:
    s_nop 15
    buffer_store_dwordx2 v[92:93], v91, s[32:35], s10 offen sc1
    s_branch back_28

.fill 4096, 4, 0xbf800000

.section .rodata,"a"
.p2align 6
.amdhsa_kernel concat_heads__sliding_block_cached__compressed_kv_cla__decode_kernel
  .amdhsa_next_free_vgpr 512
  .amdhsa_next_free_sgpr 102
  .amdhsa_accum_offset 256
  .amdhsa_group_segment_fixed_size 0
  .amdhsa_kernarg_size 112
  .amdhsa_user_sgpr_count 2
  .amdhsa_user_sgpr_kernarg_segment_ptr 1
  .amdhsa_system_sgpr_workgroup_id_x 1
.end_amdhsa_kernel
```
